```python
import torch

def _softmax(x, axis=-1):
    return torch.softmax(x, dim=axis)
def _gelu(x):
    return torch.nn.functional.gelu(x, approximate="tanh")
def _silu(x):
    return torch.nn.functional.silu(x)
def _sigmoid(x):
    return torch.sigmoid(x)
def _layernorm(x, axis=-1, eps=1e-5):
    m = x.mean(dim=axis, keepdim=True)
    v = x.var(dim=axis, keepdim=True, unbiased=False)
    return (x - m) / torch.sqrt(v + eps)
def _scatter_add(tgt, idx, src, axis=0):
    return tgt.clone().index_add_(axis, idx, src)
def _segment_sum(src, seg, n):
    out = torch.zeros((n,) + src.shape[1:], dtype=src.dtype)
    return out.index_add_(0, seg, src)
def _pad(x, pw):
    flat = tuple(v for pair in reversed(pw) for v in pair)
    return torch.nn.functional.pad(x, flat)

kernel_name = 'concat_heads__linear_attn_block__linear_kernel_hedgehog__prompt'

def setup_inputs():

    _w = (lambda a: (lambda t: t.to(torch.bfloat16) if t.is_floating_point() else t)(torch.as_tensor(a)))
    def _A_setup():
        B, S, D = 1, 2048, 448
        return {
            "x": _w((lambda *s: torch.randn(*s, dtype=torch.bfloat16) * 0.05)(B, S, D)),
            "wqkv": _w((lambda *s: torch.randn(*s, dtype=torch.bfloat16) * 0.8)(D, 3 * D)),
            "wo": _w((lambda *s: torch.randn(*s, dtype=torch.bfloat16) * 0.4)(D, D)),
        }
    _A_in = _A_setup()

    def _B_setup():
        B, S, D, H = 1, 2048, 448, 16
        Dh = D // H
        return {
            "x": _w((lambda *s: torch.randn(*s, dtype=torch.bfloat16) * 0.4)(B, S, D)),
            "wqkv": _w((lambda *s: torch.randn(*s, dtype=torch.bfloat16) * 0.4)(D, 3 * D)),
            "w_phi": _w((lambda *s: torch.randn(*s, dtype=torch.bfloat16) * 0.4)(H, Dh, Dh) * (Dh ** -0.5)),
            "wo": _w((lambda *s: torch.randn(*s, dtype=torch.bfloat16) * 0.05)(D, D)),
        }
    _B_in = _B_setup()

    return {
        "A_x": _A_in["x"],
        "A_wqkv": _A_in["wqkv"],
        "A_wo": _A_in["wo"],
        "B_x": _B_in["x"],
        "B_wqkv": _B_in["wqkv"],
        "B_w_phi": _B_in["w_phi"],
        "B_wo": _B_in["wo"],
    }

def reference(A_x, A_wqkv, A_wo, B_x, B_wqkv, B_w_phi, B_wo):
    def _A_ref(x, wqkv, wo):
        B, S, D = x.shape
        H = 16; Dh = D // H
        qkv = (lambda x, *d: x.permute(*d))((x @ wqkv).reshape(B, S, 3, H, Dh), 2, 0, 3, 1, 4)
        q, k, v = qkv[0], qkv[1], qkv[2]
        phi = lambda t: torch.where(t > 0, t + 1, torch.exp(t)) + 1e-6
        pq, pk = phi(q), phi(k)
        kv = torch.einsum("bhsd,bhse->bhde", pk, v)
        z = torch.einsum("bhsd->bhd", pk)
        num = torch.einsum("bhqd,bhde->bhqe", pq, kv)
        den = torch.einsum("bhqd,bhd->bhq", pq, z)[..., None] + 1e-6
        o = num / den
        return (lambda x, *d: x.permute(*d))(o, 0, 2, 1, 3).reshape(B, S, D) @ wo

    def _B_ref(x, wqkv, w_phi, wo):
        B, S, D = x.shape
        H = 16; Dh = D // H
        qkv = (lambda x, *d: x.permute(*d))((x @ wqkv).reshape(B, S, 3, H, Dh), 2, 0, 3, 1, 4)
        q, k, v = qkv[0], qkv[1], qkv[2]
        pq = torch.einsum("bhsd,hdf->bhsf", q, w_phi)
        pk = torch.einsum("bhsd,hdf->bhsf", k, w_phi)
        phi_q = torch.concatenate([_softmax(pq, axis=-1), _softmax(-pq, axis=-1)], axis=-1)
        phi_k = torch.concatenate([_softmax(pk, axis=-1), _softmax(-pk, axis=-1)], axis=-1)
        kv = torch.einsum("bhsf,bhsd->bhfd", phi_k, v)
        z  = torch.einsum("bhsf->bhf", phi_k)
        num = torch.einsum("bhqf,bhfd->bhqd", phi_q, kv)
        den = torch.einsum("bhqf,bhf->bhq", phi_q, z)[..., None] + 1e-6
        o = num / den
        return (lambda x, *d: x.permute(*d))(o, 0, 2, 1, 3).reshape(B, S, D) @ wo

    a = _A_ref(A_x, A_wqkv, A_wo)
    b = _B_ref(B_x, B_wqkv, B_w_phi, B_wo)
    return torch.concatenate([a, b], axis=-1)
```

```asm
; @launch grid=(256,1,1) block=(256,1,1) lds=163840
.amdgcn_target "amdgcn-amd-amdhsa--gfx950"
.text
.globl concat_heads__linear_attn_block__linear_kernel_hedgehog__prompt_kernel
.p2align 8
.type concat_heads__linear_attn_block__linear_kernel_hedgehog__prompt_kernel,@function
concat_heads__linear_attn_block__linear_kernel_hedgehog__prompt_kernel:
    s_load_dwordx16 s[4:19], s[0:1], 0
    s_load_dwordx4 s[20:23], s[0:1], 64
    s_cmpk_ge_u32 s2, 0x100
    s_cbranch_scc1 L_end
    v_readfirstlane_b32 s51, v0
    v_and_b32 v1, 63, v0
    s_lshr_b32 s53, s2, 3
    s_and_b32 s50, s53, 15
    s_lshr_b32 s56, s53, 4
    s_bitcmp0_b32 s2, 2
    s_cselect_b32 s87, 136, 0
    s_lshl3_add_u32 s87, s53, s87
    v_lshrrev_b32 v19, 5, v0
    s_getpc_b64 s[54:55]
    v_add_lshl_u32 v19, v19, s87, 7
    global_load_dword v18, v19, s[54:55]
    s_and_b32 s49, s2, 3
    s_lshl1_add_u32 s49, s49, s56
    s_lshr_b32 s51, s51, 6
    s_mul_i32 s56, s56, 3
    s_add_u32 s93, s50, s56
    s_mul_i32 s87, s93, 37
    s_lshr_b32 s87, s87, 8
    s_mul_i32 s87, s87, 7
    s_sub_u32 s93, s93, s87
    s_lshl2_add_u32 s87, s49, s51
    s_mul_i32 s94, s87, 57344
    s_lshl_b32 s89, s93, 7
    s_add_u32 s64, s94, s89
    s_lshl_b32 s80, s51, 12
    s_mov_b32 m0, s80
    v_lshrrev_b32 v232, 3, v1
    v_mul_u32_u24 v232, 896, v232
    v_lshrrev_b32 v233, 4, v1
    v_and_b32 v234, 7, v1
    v_xor_b32 v234, v233, v234
    v_lshl_add_u32 v2, v234, 4, v232
    v_xor_b32 v234, 64, v2
    v_add_u32 v3, 6144, v234
    v_add_u32 v4, 12288, v2
    v_add_u32 v5, 18432, v234
    s_mov_b32 s26, 1835008
    s_mov_b32 s27, 0x20000
    s_bitcmp0_b32 s2, 2
    s_waitcnt lgkmcnt(0)
    s_cselect_b32 s24, s4, s10
    s_cselect_b32 s25, s5, s11
    buffer_load_dwordx4 v2, s[24:27], s64 offen offset:0  lds
    buffer_load_dwordx4 v3, s[24:27], s64 offen offset:1024  lds
    buffer_load_dwordx4 v4, s[24:27], s64 offen offset:2048  lds
    buffer_load_dwordx4 v5, s[24:27], s64 offen offset:3072  lds
    s_cselect_b32 s28, s6, s12
    s_cselect_b32 s29, s7, s13
    s_cselect_b32 s32, s8, s16
    s_cselect_b32 s33, s9, s17
    s_cselect_b32 s38, 0, 25088
    s_sub_u32 s28, s28, 4096
    s_subb_u32 s29, s29, 0
    s_mov_b32 s30, 1208320
    s_mov_b32 s31, s27
    v_lshrrev_b32 v232, 2, v1
    v_mul_u32_u24 v232, 2688, v232
    v_and_b32 v234, 3, v1
    v_lshl_add_u32 v253, v234, 4, v232
    v_add_u32 v6, 896, v253
    s_cmp_eq_u32 s50, 15
    s_cselect_b32 s82, 8, 0
    s_mul_i32 s88, s50, 56
    s_sub_u32 s88, s88, s82
    s_mul_i32 s89, s51, 43008
    s_add_u32 s95, s88, s89
    s_mul_i32 s3, s51, 7168
    s_mul_i32 s89, s93, 172032
    s_add_u32 s89, s95, s89
    s_add_u32 s72, s89, 4096
    s_add_u32 m0, s3, 98304
    s_nop 0
    buffer_load_dwordx4 v6, s[28:31], s72 offen offset:0  lds
    s_add_u32 s93, s93, 1
    s_cmp_eq_u32 s93, 7
    s_cselect_b32 s93, 0, s93
    s_lshl_b32 s89, s93, 7
    s_add_u32 s65, s94, s89
    s_mul_i32 s89, s93, 172032
    s_add_u32 s89, s95, s89
    s_add_u32 s73, s89, 3072
    s_add_u32 s93, s93, 1
    s_cmp_eq_u32 s93, 7
    s_cselect_b32 s93, 0, s93
    buffer_load_dwordx4 v6, s[28:31], s73 offen offset:1024  lds
    s_bfe_u32 s48, s2, 0x10002
    s_lshl_b32 s81, s51, 10
    s_mov_b32 s34, 401408
    s_mov_b32 s35, 0x20000
    s_mov_b32 s42, 33554432
    s_mov_b32 s43, 0x20000
    s_mov_b32 s46, 3670016
    s_mov_b32 s47, 0x20000
    s_mov_b32 s36, s14
    s_mov_b32 s37, s15
    s_mov_b32 s39, 0x20000
    v_lshlrev_b32 v249, 4, v1
    s_cmp_ge_u32 s51, 2
    s_cselect_b32 s86, 0x40000000, s81
    v_add_u32 v232, s86, v249
    s_mul_i32 s56, s50, 1568
    s_add_u32 m0, s81, 155648
    s_nop 0
    buffer_load_dwordx4 v232, s[36:39], s56 offen lds
    s_add_u32 m0, s80, 16384
    s_nop 0
    buffer_load_dwordx4 v2, s[24:27], s65 offen offset:0  lds
    buffer_load_dwordx4 v3, s[24:27], s65 offen offset:1024  lds
    buffer_load_dwordx4 v4, s[24:27], s65 offen offset:2048  lds
    buffer_load_dwordx4 v5, s[24:27], s65 offen offset:3072  lds
    s_mov_b32 s40, s22
    s_mov_b32 s41, s23
    s_mov_b32 s44, s18
    s_mov_b32 s45, s19
    v_mov_b32 v9, 0
    s_cmp_eq_u32 s48, 0
    s_cbranch_scc1 L_pathA
    s_load_dwordx2 s[10:11], s[22:23], 128
    s_lshl_b32 s89, s93, 7
    s_add_u32 s66, s94, s89
    s_mul_i32 s89, s93, 172032
    s_add_u32 s89, s95, s89
    s_add_u32 s74, s89, 2048
    s_add_u32 s93, s93, 1
    s_cmp_eq_u32 s93, 7
    s_cselect_b32 s93, 0, s93
    s_lshl_b32 s89, s93, 7
    s_add_u32 s67, s94, s89
    s_mul_i32 s89, s93, 172032
    s_add_u32 s89, s95, s89
    s_add_u32 s75, s89, 1024
    s_add_u32 s93, s93, 1
    s_cmp_eq_u32 s93, 7
    s_cselect_b32 s93, 0, s93
    s_lshl_b32 s89, s93, 7
    s_add_u32 s68, s94, s89
    s_mul_i32 s89, s93, 172032
    s_add_u32 s89, s95, s89
    s_add_u32 s76, s89, 4096
    s_add_u32 s93, s93, 1
    s_cmp_eq_u32 s93, 7
    s_cselect_b32 s93, 0, s93
    s_lshl_b32 s89, s93, 7
    s_add_u32 s69, s94, s89
    s_mul_i32 s89, s93, 172032
    s_add_u32 s89, s95, s89
    s_add_u32 s77, s89, 3072
    s_add_u32 s93, s93, 1
    s_cmp_eq_u32 s93, 7
    s_cselect_b32 s93, 0, s93
    v_and_b32 v235, 31, v1
    s_lshl_b32 s89, s93, 7
    v_lshrrev_b32 v236, 5, v1
    v_bfe_u32 v233, v235, 1, 3
    s_add_u32 s70, s94, s89
    s_mul_i32 s89, s93, 172032
    s_add_u32 s89, s95, s89
    s_add_u32 s78, s89, 2048
    s_add_u32 m0, s3, 98304
    v_xor_b32 v233, v233, v236
    buffer_load_dwordx4 v6, s[28:31], s74 offen offset:2048  lds
    s_add_u32 m0, s3, 98304
    v_lshl_add_u32 v234, v235, 7, s80
    buffer_load_dwordx4 v6, s[28:31], s75 offen offset:3072  lds
    s_add_u32 m0, s80, 32768
    v_xor_b32 v237, 0, v233
    buffer_load_dwordx4 v2, s[24:27], s66 offen offset:0  lds
    v_lshl_add_u32 v10, v237, 4, v234
    v_xor_b32 v237, 2, v233
    v_lshl_add_u32 v11, v237, 4, v234
    buffer_load_dwordx4 v3, s[24:27], s66 offen offset:1024  lds
    v_xor_b32 v237, 4, v233
    v_lshl_add_u32 v12, v237, 4, v234
    v_xor_b32 v237, 6, v233
    v_lshl_add_u32 v13, v237, 4, v234
    v_bfe_u32 v233, v1, 2, 2
    v_and_b32 v238, 3, v1
    v_lshlrev_b32 v234, 6, v233
    v_bfe_u32 v237, v1, 4, 1
    v_lshlrev_b32_e64 v238, 3, v238
    v_lshl_add_u32 v234, v236, 9, v234
    v_lshl_add_u32 v238, v237, 5, v238
    v_add3_u32 v7, v234, v238, s82
    v_add_u32 v8, 98304, v7
    s_mul_i32 s86, s53, 98
    s_mul_i32 s87, s51, 25
    v_min_u32 v232, 24, v1
    v_xor_b32 v237, s51, v233
    v_lshl_add_u32 v238, v237, 6, v238
    v_lshl_add_u32 v238, v233, 8, v238
    v_lshrrev_b32 v237, 4, v1
    v_lshl_add_u32 v238, v237, 11, v238
    v_add_u32 v250, 32768, v238
    v_mul_u32_u24 v237, 224, v236
    v_cmp_lt_u32_e64 s[60:61], 31, v1
    v_and_b32 v255, 7, v1
    v_mov_b32 v234, 157696
    v_bfe_u32 v240, v1, 3, 2
    v_lshlrev_b32 v255, 7, v255
    v_lshl_add_u32 v255, v240, 14, v255
    v_lshrrev_b32_e64 v240, 4, v1
    s_waitcnt vmcnt(8)
    s_barrier
    ds_read_b64_tr_b16 a[224:225], v8 offset:0
    ds_read_b64_tr_b16 a[226:227], v8 offset:256
    ds_read_b128 a[0:3], v10 offset:0
    ds_read_b64_tr_b16 a[228:229], v8 offset:7168
    ds_read_b64_tr_b16 a[230:231], v8 offset:7424
    ds_read_b128 a[8:11], v11 offset:0
    buffer_load_dwordx4 v4, s[24:27], s66 offen offset:2048  lds
    ds_read_b64_tr_b16 a[232:233], v8 offset:14336
    ds_read_b64_tr_b16 a[234:235], v8 offset:14592
    ds_read_b128 a[16:19], v12 offset:0
    v_bfe_u32 v241, v1, 2, 2
    v_xor_b32_e64 v241, v241, v240
    v_mul_u32_u24 v240, 896, v240
    ds_read_b64_tr_b16 a[236:237], v8 offset:21504
    ds_read_b64_tr_b16 a[238:239], v8 offset:21760
    ds_read_b128 a[24:27], v13 offset:0
    v_lshl_add_u32 v240, v241, 6, v240
    v_and_b32 v242, 3, v1
    v_lshl_add_u32 v240, v242, 4, v240
    v_mov_b32 v242, 0x40000000
    v_add_u32 v251, 1792, v253
    s_mov_b32 s71, 0
    s_getreg_b32 s57, hwreg(HW_REG_XCC_ID, 0, 4)
    v_add_u32 v14, 0x10000, v10
    v_add_u32 v15, 0x10000, v11
    v_add_u32 v16, 0x10000, v12
    v_add_u32 v17, 0x10000, v13
    v_cmp_eq_u32_e64 s[62:63], 28, v235
    s_waitcnt lgkmcnt(8)
    v_mfma_f32_32x32x16_bf16 v[40:55], a[224:227], a[0:3], 0
    v_mov_b32 v36, 0x3fb8aa3b
    s_waitcnt lgkmcnt(6)
    v_mfma_f32_32x32x16_bf16 v[40:55], a[228:231], a[8:11], v[40:55]
    s_waitcnt lgkmcnt(3)
    v_mfma_f32_32x32x16_bf16 v[40:55], a[232:235], a[16:19], v[40:55]
    buffer_load_dwordx4 v5, s[24:27], s66 offen offset:3072  lds
    s_add_u32 m0, s3, 102400
    s_waitcnt lgkmcnt(0)
    v_mfma_f32_32x32x16_bf16 v[40:55], a[236:239], a[24:27], v[40:55]
    s_waitcnt vmcnt(6)
    ds_read_b64_tr_b16 a[240:241], v8 offset:1024
    ds_read_b64_tr_b16 a[242:243], v8 offset:1280
    ds_read_b128 a[32:35], v10 offset:16384
    ds_read_b64_tr_b16 a[244:245], v8 offset:8192
    ds_read_b64_tr_b16 a[246:247], v8 offset:8448
    ds_read_b128 a[40:43], v11 offset:16384
    ds_read_b64_tr_b16 a[248:249], v8 offset:15360
    ds_read_b64_tr_b16 a[250:251], v8 offset:15616
    buffer_load_dwordx4 v6, s[28:31], s76 offen offset:0  lds
    s_add_u32 m0, s80, 49152
    ds_read_b128 a[48:51], v12 offset:16384
    ds_read_b64_tr_b16 a[252:253], v8 offset:22528
    ds_read_b64_tr_b16 a[254:255], v8 offset:22784
    ds_read_b128 a[56:59], v13 offset:16384
    buffer_load_dwordx4 v2, s[24:27], s67 offen offset:0  lds
    s_waitcnt lgkmcnt(9)
    v_mfma_f32_32x32x16_bf16 v[40:55], a[240:243], a[32:35], v[40:55]
    s_waitcnt lgkmcnt(6)
    v_mfma_f32_32x32x16_bf16 v[40:55], a[244:247], a[40:43], v[40:55]
    buffer_load_dwordx4 v3, s[24:27], s67 offen offset:1024  lds
    s_waitcnt lgkmcnt(3)
    v_mfma_f32_32x32x16_bf16 v[40:55], a[248:251], a[48:51], v[40:55]
    s_waitcnt lgkmcnt(0)
    v_mfma_f32_32x32x16_bf16 v[40:55], a[252:255], a[56:59], v[40:55]
    buffer_load_dwordx4 v4, s[24:27], s67 offen offset:2048  lds
    buffer_load_dwordx4 v5, s[24:27], s67 offen offset:3072  lds
    s_add_u32 m0, s3, 102400
    s_nop 0
    buffer_load_dwordx4 v6, s[28:31], s77 offen offset:1024  lds
    s_add_u32 m0, s3, 102400
    s_add_u32 s86, s86, s87
    v_add_u32 v232, s86, v232
    s_and_b32 s86, s51, 1
    s_lshl_b32 s86, s86, 4
    s_bitcmp1_b32 s51, 1
    s_cselect_b32 s82, 0x80008000, 0
    s_lshl_b32 s52, s48, 3
    s_add_u32 s52, s52, s49
    s_and_b32 s83, s50, 3
    s_lshr_b32 s84, s50, 2
    s_lshl_b32 s98, s52, 4
    s_add_u32 s85, s98, s50
    s_lshl2_add_u32 s98, s52, s51
    s_lshl_b32 s98, s98, 6
    s_add_u32 s98, s98, s50
    buffer_load_dwordx4 v6, s[28:31], s78 offen offset:2048  lds
    v_min_u32 v232, 3135, v232
    s_lshl_b32 s96, s98, 10
    v_lshlrev_b32 v254, 7, v232
    v_xor_b32 v238, s86, v235
    s_add_u32 s96, s96, 2097152
    v_lshrrev_b32 v232, 3, v238
    v_and_b32 v233, 3, v238
    s_and_b32 s90, s50, 0
    v_lshl_add_u32 v232, v232, 2, v233
    s_lshl_b32 s90, s90, 15
    v_lshrrev_b32 v233, 4, v238
    s_add_u32 s90, s90, s96
    v_sub_u32 v232, v232, v233
    s_lshl_b32 s98, s52, 9
    v_bfe_u32 v233, v235, 2, 1
    s_add_u32 s98, s98, 8192
    v_mad_u32_u24 v232, v233, 14, v232
    s_lshl_b32 s53, s51, 7
    v_and_b32 v233, 11, v235
    s_add_u32 s53, s53, s98
    v_cmp_eq_u32 vcc, 11, v233
    s_lshl_b32 s97, s84, 7
    v_lshl_add_u32 v237, v232, 1, v237
    s_add_u32 s97, s97, s98
    v_add_u32 v237, 155648, v237
    s_cmp_eq_u32 s83, 3
    v_cndmask_b32_e64 v244, v237, v234, vcc
    ds_read_u16 v104, v244 offset:0
    ds_read_u16 v105, v244 offset:56
    ds_read_u16 v106, v244 offset:112
    ds_read_u16 v107, v244 offset:168
    ds_read_u16 v108, v244 offset:448
    ds_read_u16 v109, v244 offset:504
    ds_read_u16 v110, v244 offset:560
    ds_read_u16 v111, v244 offset:616
    ds_read_u16 v112, v244 offset:896
    ds_read_u16 v113, v244 offset:952
    ds_read_u16 v114, v244 offset:1008
    ds_read_u16 v115, v244 offset:1064
    s_cselect_b32 s98, 1, 3
    v_cndmask_b32_e64 v245, v244, v234, s[60:61]
    ds_read_u16 v116, v245 offset:1344
    ds_read_u16 v117, v245 offset:1400
    ds_read_u16 v118, v245 offset:1456
    ds_read_u16 v119, v245 offset:1512
    s_lshl_b32 s79, s85, 3
    s_add_u32 s79, s79, 4096
    v_cndmask_b32_e64 v243, v232, 63, vcc
    s_lshl1_add_u32 s7, s48, 1
    v_cmp_lt_u32 vcc, s98, v241
    s_and_b32 s7, s7, s51
    s_lshl_b32 s98, s48, 4
    s_add_u32 s98, s98, s50
    v_cndmask_b32_e64 v252, v240, v242, vcc
    s_lshl2_add_u32 s98, s98, s7
    v_and_b32 v240, 1, v1
    v_and_b32 v241, 2, v1
    s_lshl_b32 s98, s98, 13
    v_cmp_eq_u32 vcc, 0, v1
    v_cmp_ne_u32_e64 s[36:37], 0, v240
    v_cmp_ne_u32_e64 s[38:39], 0, v241
    s_add_u32 s5, s98, 65536
    s_add_u32 s6, s5, 4096
    v_lshrrev_b32 v240, 3, v235
    v_bfe_u32 v241, v235, 1, 1
    s_lshl_b32 s98, s49, 10
    v_lshl_add_u32 v240, v240, 1, v241
    v_cndmask_b32_e64 v19, v242, 0, vcc
    s_add_u32 s4, s5, s98
    v_and_b32 v241, 1, v235
    s_lshl_b32 s7, s7, 10
    v_lshlrev_b32 v241, 4, v241
    v_mov_b32 v242, 0x3f80
    s_and_b32 s8, s79, 0xffffff80
    v_lshlrev_b32_e64 v242, v241, v242
    s_add_u32 s9, s80, 32768
    s_add_u32 m0, s80, 65536
    v_bfe_u32 v241, v235, 2, 1
    buffer_load_dwordx4 v2, s[24:27], s68 offen offset:0  lds
    buffer_load_dwordx4 v3, s[24:27], s68 offen offset:1024  lds
    buffer_load_dwordx4 v4, s[24:27], s68 offen offset:2048  lds
    v_cmp_eq_u32 vcc, v241, v236
    s_waitcnt lgkmcnt(0)
    v_lshl_or_b32 v20, v105, 16, v104
    v_lshl_or_b32 v21, v107, 16, v106
    v_cndmask_b32_e64 v240, 15, v240, vcc
    v_cmp_eq_u32_e64 s[58:59], 0, v240
    v_cmp_eq_u32_e64 s[54:55], 1, v240
    v_lshl_or_b32 v22, v109, 16, v108
    v_cndmask_b32_e64 v28, 0, v242, s[58:59]
    v_cndmask_b32_e64 v29, 0, v242, s[54:55]
    v_cmp_eq_u32_e64 s[58:59], 2, v240
    v_cmp_eq_u32_e64 s[54:55], 3, v240
    v_lshl_or_b32 v23, v111, 16, v110
    v_cndmask_b32_e64 v30, 0, v242, s[58:59]
    v_cndmask_b32_e64 v31, 0, v242, s[54:55]
    v_cmp_eq_u32_e64 s[58:59], 4, v240
    v_cmp_eq_u32_e64 s[54:55], 5, v240
    v_lshl_or_b32 v24, v113, 16, v112
    v_cndmask_b32_e64 v32, 0, v242, s[58:59]
    v_cndmask_b32_e64 v33, 0, v242, s[54:55]
    v_cmp_eq_u32_e64 s[58:59], 6, v240
    v_cmp_eq_u32_e64 s[54:55], 7, v240
    v_lshl_or_b32 v25, v115, 16, v114
    v_lshl_or_b32 v26, v117, 16, v116
    v_lshl_or_b32 v27, v119, 16, v118
    v_cndmask_b32_e64 v34, 0, v242, s[58:59]
    v_cndmask_b32_e64 v35, 0, v242, s[54:55]
    v_xor_b32 v20, s82, v20
    v_xor_b32 v21, s82, v21
    v_xor_b32 v22, s82, v22
    buffer_load_dwordx4 v5, s[24:27], s68 offen offset:3072  lds
    s_add_u32 m0, s80, 81920
    v_xor_b32 v23, s82, v23
    v_xor_b32 v24, s82, v24
    v_xor_b32 v25, s82, v25
    v_xor_b32 v26, s82, v26
    v_xor_b32 v27, s82, v27
    buffer_load_dwordx4 v2, s[24:27], s69 offen offset:0  lds
    buffer_load_dwordx4 v3, s[24:27], s69 offen offset:1024  lds
    buffer_load_dwordx4 v4, s[24:27], s69 offen offset:2048  lds
    buffer_load_dwordx4 v5, s[24:27], s69 offen offset:3072  lds
    s_waitcnt lgkmcnt(0)
    s_waitcnt vmcnt(15)
    s_barrier
    ds_read_b64_tr_b16 a[224:225], v8 offset:2048
    ds_read_b64_tr_b16 a[226:227], v8 offset:2304
    ds_read_b128 a[64:67], v10 offset:32768
    ds_read_b64_tr_b16 a[228:229], v8 offset:9216
    ds_read_b64_tr_b16 a[230:231], v8 offset:9472
    ds_read_b128 a[72:75], v11 offset:32768
    s_add_u32 s58, s10, 0x9e3679b8
    s_add_u32 s59, s11, 0x85eaca6a
    ds_read_b64_tr_b16 a[232:233], v8 offset:16384
    ds_read_b64_tr_b16 a[234:235], v8 offset:16640
    ds_read_b128 a[80:83], v12 offset:32768
    s_or_b32 s58, s58, 0x00010001
    s_and_b32 s58, s58, 0xbfffbfff
    ds_read_b64_tr_b16 a[236:237], v8 offset:23552
    ds_read_b64_tr_b16 a[238:239], v8 offset:23808
    ds_read_b128 a[88:91], v13 offset:32768
    s_waitcnt vmcnt(10)
    ds_read_b64_tr_b16 a[240:241], v8 offset:3072
    ds_read_b64_tr_b16 a[242:243], v8 offset:3328
    ds_read_b128 a[96:99], v10 offset:49152
    s_or_b32 s59, s59, 0x00010001
    s_and_b32 s59, s59, 0xbfffbfff
    ds_read_b64_tr_b16 a[244:245], v8 offset:10240
    s_waitcnt lgkmcnt(13)
    v_mfma_f32_32x32x16_bf16 v[40:55], a[224:227], a[64:67], v[40:55]
    ds_read_b64_tr_b16 a[246:247], v8 offset:10496
    ds_read_b128 a[104:107], v11 offset:49152
    s_and_b32 s11, s59, 0xfffffff0
    ds_read_b64_tr_b16 a[248:249], v8 offset:17408
    s_waitcnt lgkmcnt(13)
    v_mfma_f32_32x32x16_bf16 v[40:55], a[228:231], a[72:75], v[40:55]
    ds_read_b64_tr_b16 a[250:251], v8 offset:17664
    ds_read_b128 a[112:115], v12 offset:49152
    s_or_b32 s99, s57, s11
    s_add_u32 m0, s80, 0
    ds_read_b64_tr_b16 a[252:253], v8 offset:24576
    s_waitcnt lgkmcnt(13)
    v_mfma_f32_32x32x16_bf16 v[40:55], a[232:235], a[80:83], v[40:55]
    buffer_load_dwordx4 v2, s[24:27], s70 offen offset:0  lds
    buffer_load_dwordx4 v3, s[24:27], s70 offen offset:1024  lds
    buffer_load_dwordx4 v4, s[24:27], s70 offen offset:2048  lds
    s_waitcnt lgkmcnt(10)
    v_mfma_f32_32x32x16_bf16 v[40:55], a[236:239], a[88:91], v[40:55]
    buffer_load_dwordx4 v5, s[24:27], s70 offen offset:3072  lds
    s_add_u32 m0, s80, 16384
    s_add_u32 s64, s64, 28672
    ds_read_b64_tr_b16 a[254:255], v8 offset:24832
    s_waitcnt lgkmcnt(7)
    v_mfma_f32_32x32x16_bf16 v[40:55], a[240:243], a[96:99], v[40:55]
    ds_read_b128 a[120:123], v13 offset:49152
    buffer_load_dwordx4 v2, s[24:27], s64 offen offset:0  lds
    v_mov_b32 v38, s58
    s_waitcnt lgkmcnt(6)
    v_mfma_f32_32x32x16_bf16 v[40:55], a[244:247], a[104:107], v[40:55]
    v_mov_b32 v39, s59
    v_cndmask_b32_e64 v246, v38, v39, s[38:39]
    v_lshlrev_b32 v247, 16, v246
    v_and_b32 v246, 0xffff0000, v246
    v_cndmask_b32_e64 v248, v247, v246, s[36:37]
    s_waitcnt lgkmcnt(3)
    v_mfma_f32_32x32x16_bf16 v[40:55], a[248:251], a[112:115], v[40:55]
    buffer_load_dwordx4 v3, s[24:27], s64 offen offset:1024  lds
    s_waitcnt vmcnt(10)
    s_barrier
    ds_read_b64_tr_b16 a[224:225], v8 offset:4096
    ds_read_b64_tr_b16 a[226:227], v8 offset:4352
    ds_read_b128 a[128:131], v14 offset:0
    ds_read_b64_tr_b16 a[228:229], v8 offset:11264
    ds_read_b64_tr_b16 a[230:231], v8 offset:11520
    ds_read_b128 a[136:139], v15 offset:0
    v_mov_b32_e64 v39, s99
    ds_read_b64_tr_b16 a[232:233], v8 offset:18432
    ds_read_b64_tr_b16 a[234:235], v8 offset:18688
    s_waitcnt lgkmcnt(8)
    v_mfma_f32_32x32x16_bf16 v[40:55], a[252:255], a[120:123], v[40:55]
    buffer_load_dwordx4 v4, s[24:27], s64 offen offset:2048  lds
    ds_read_b128 a[144:147], v16 offset:0
    ds_read_b64_tr_b16 a[236:237], v8 offset:25600
    ds_read_b64_tr_b16 a[238:239], v8 offset:25856
    ds_read_b128 a[152:155], v17 offset:0
    buffer_load_dwordx4 v5, s[24:27], s64 offen offset:3072  lds
    s_add_u32 m0, s80, 32768
    s_add_u32 s65, s65, 28672
    s_waitcnt lgkmcnt(9)
    v_mfma_f32_32x32x16_bf16 v[40:55], a[224:227], a[128:131], v[40:55]
    s_waitcnt lgkmcnt(6)
    v_mfma_f32_32x32x16_bf16 v[40:55], a[228:231], a[136:139], v[40:55]
    buffer_load_dwordx4 v2, s[24:27], s65 offen offset:0  lds
    s_waitcnt lgkmcnt(3)
    v_mfma_f32_32x32x16_bf16 v[40:55], a[232:235], a[144:147], v[40:55]
    s_waitcnt lgkmcnt(0)
    v_mfma_f32_32x32x16_bf16 v[40:55], a[236:239], a[152:155], v[40:55]
    s_waitcnt vmcnt(9)
    ds_read_b64_tr_b16 a[240:241], v8 offset:5120
    buffer_load_dwordx4 v3, s[24:27], s65 offen offset:1024  lds
    ds_read_b64_tr_b16 a[242:243], v8 offset:5376
    ds_read_b128 a[160:163], v14 offset:16384
    ds_read_b64_tr_b16 a[244:245], v8 offset:12288
    ds_read_b64_tr_b16 a[246:247], v8 offset:12544
    ds_read_b128 a[168:171], v15 offset:16384
    ds_read_b64_tr_b16 a[248:249], v8 offset:19456
    ds_read_b64_tr_b16 a[250:251], v8 offset:19712
    ds_read_b128 a[176:179], v16 offset:16384
    buffer_load_dwordx4 v4, s[24:27], s65 offen offset:2048  lds
    ds_read_b64_tr_b16 a[252:253], v8 offset:26624
    ds_read_b64_tr_b16 a[254:255], v8 offset:26880
    ds_read_b128 a[184:187], v17 offset:16384
    buffer_load_dwordx4 v5, s[24:27], s65 offen offset:3072  lds
    s_waitcnt lgkmcnt(9)
    v_mfma_f32_32x32x16_bf16 v[40:55], a[240:243], a[160:163], v[40:55]
    s_add_u32 m0, s80, 49152
    s_add_u32 s66, s66, 28672
    s_waitcnt lgkmcnt(6)
    v_mfma_f32_32x32x16_bf16 v[40:55], a[244:247], a[168:171], v[40:55]
    buffer_load_dwordx4 v2, s[24:27], s66 offen offset:0  lds
    s_waitcnt lgkmcnt(3)
    v_mfma_f32_32x32x16_bf16 v[40:55], a[248:251], a[176:179], v[40:55]
    s_waitcnt lgkmcnt(0)
    v_mfma_f32_32x32x16_bf16 v[40:55], a[252:255], a[184:187], v[40:55]
    s_waitcnt vmcnt(9)
    ds_read_b64_tr_b16 a[224:225], v8 offset:6144
    buffer_load_dwordx4 v3, s[24:27], s66 offen offset:1024  lds
    ds_read_b64_tr_b16 a[226:227], v8 offset:6400
    ds_read_b128 a[192:195], v10 offset:0
    ds_read_b64_tr_b16 a[228:229], v8 offset:13312
    ds_read_b64_tr_b16 a[230:231], v8 offset:13568
    ds_read_b128 a[200:203], v11 offset:0
    ds_read_b64_tr_b16 a[232:233], v8 offset:20480
    ds_read_b64_tr_b16 a[234:235], v8 offset:20736
    ds_read_b128 a[208:211], v12 offset:0
    buffer_load_dwordx4 v4, s[24:27], s66 offen offset:2048  lds
    ds_read_b64_tr_b16 a[236:237], v8 offset:27648
    ds_read_b64_tr_b16 a[238:239], v8 offset:27904
    ds_read_b128 a[216:219], v13 offset:0
    buffer_load_dwordx4 v5, s[24:27], s66 offen offset:3072  lds
    s_waitcnt lgkmcnt(9)
    v_mfma_f32_32x32x16_bf16 v[40:55], a[224:227], a[192:195], v[40:55]
    s_add_u32 m0, s80, 65536
    s_add_u32 s67, s67, 28672
    s_waitcnt lgkmcnt(6)
    v_mfma_f32_32x32x16_bf16 v[40:55], a[228:231], a[200:203], v[40:55]
    buffer_load_dwordx4 v2, s[24:27], s67 offen offset:0  lds
    s_waitcnt lgkmcnt(3)
    v_mfma_f32_32x32x16_bf16 v[40:55], a[232:235], a[208:211], v[40:55]
    s_waitcnt lgkmcnt(0)
    v_mfma_f32_32x32x16_bf16 v[40:55], a[236:239], a[216:219], v[40:55]
    buffer_load_dwordx4 v3, s[24:27], s67 offen offset:1024  lds
    buffer_load_dwordx4 v4, s[24:27], s67 offen offset:2048  lds
    buffer_load_dwordx4 v5, s[24:27], s67 offen offset:3072  lds
    s_add_u32 m0, s80, 81920
    s_add_u32 s68, s68, 28672
    s_waitcnt vmcnt(12)
    ds_read_b64_tr_b16 a[240:241], v8 offset:0
    ds_read_b64_tr_b16 a[242:243], v8 offset:256
    ds_read_b128 a[4:7], v10 offset:16384
    ds_read_b64_tr_b16 a[244:245], v8 offset:7168
    ds_read_b64_tr_b16 a[246:247], v8 offset:7424
    ds_read_b128 a[12:15], v11 offset:16384
    v_cvt_pk_bf16_f32 v40, v40, v41
    v_cvt_pk_bf16_f32 v41, v42, v43
    v_cvt_pk_bf16_f32 v42, v44, v45
    ds_read_b64_tr_b16 a[248:249], v8 offset:14336
    ds_read_b64_tr_b16 a[250:251], v8 offset:14592
    ds_read_b128 a[20:23], v12 offset:16384
    v_cvt_pk_bf16_f32 v43, v46, v47
    v_cvt_pk_bf16_f32 v46, v52, v53
    v_cvt_pk_bf16_f32 v47, v54, v55
    v_mfma_f32_32x32x16_bf16 v[104:119], v[20:23], v[40:43], 0
    ds_read_b64_tr_b16 a[252:253], v8 offset:21504
    ds_read_b64_tr_b16 a[254:255], v8 offset:21760
    ds_read_b128 a[28:31], v13 offset:16384
    buffer_load_dwordx4 v2, s[24:27], s68 offen offset:0  lds
    v_cvt_pk_bf16_f32 v44, v48, v49
    v_cvt_pk_bf16_f32 v45, v50, v51
    v_cndmask_b32_e64 v46, v46, 0, s[60:61]
    s_waitcnt vmcnt(9)
    v_cndmask_b32_e64 v47, v47, 0, s[60:61]
    s_nop 1
    v_mfma_f32_32x32x16_bf16 v[104:119], v[24:27], v[44:47], v[104:119]
    buffer_load_dwordx4 v3, s[24:27], s68 offen offset:1024  lds
    ds_read_b64_tr_b16 a[224:225], v8 offset:1024
    ds_read_b64_tr_b16 a[226:227], v8 offset:1280
    ds_read_b128 a[36:39], v10 offset:32768
    ds_read_b64_tr_b16 a[228:229], v8 offset:8192
    s_waitcnt lgkmcnt(10)
    v_mfma_f32_32x32x16_bf16 v[56:71], a[240:243], a[4:7], 0
    ds_read_b64_tr_b16 a[230:231], v8 offset:8448
    ds_read_b128 a[44:47], v11 offset:32768
    ds_read_b64_tr_b16 a[232:233], v8 offset:15360
    buffer_load_dwordx4 v4, s[24:27], s68 offen offset:2048  lds
    v_mfma_f32_32x32x16_bf16 v[56:71], a[244:247], a[12:15], v[56:71]
    ds_read_b64_tr_b16 a[234:235], v8 offset:15616
    ds_read_b128 a[52:55], v12 offset:32768
    ds_read_b64_tr_b16 a[236:237], v8 offset:22528
    ds_read_b64_tr_b16 a[238:239], v8 offset:22784
    s_waitcnt lgkmcnt(11)
    v_mfma_f32_32x32x16_bf16 v[56:71], a[248:251], a[20:23], v[56:71]
    ds_read_b128 a[60:63], v13 offset:32768
    v_max3_f32 v232, v104, v105, v106
    v_max3_f32 v233, v112, v113, v114
    v_max3_f32 v234, -v104, -v105, -v106
    v_mfma_f32_32x32x16_bf16 v[56:71], a[252:255], a[28:31], v[56:71]
    buffer_load_dwordx4 v5, s[24:27], s68 offen offset:3072  lds
    s_add_u32 m0, s80, 0
    s_add_u32 s69, s69, 28672
    v_max3_f32 v235, -v112, -v113, -v114
    s_waitcnt lgkmcnt(9)
    v_mfma_f32_32x32x16_bf16 v[56:71], a[224:227], a[36:39], v[56:71]
    v_max3_f32 v232, v232, v107, v108
    v_max3_f32 v233, v233, v115, v116
    v_max3_f32 v234, v234, -v107, -v108
    v_max3_f32 v235, v235, -v115, -v116
    v_max3_f32 v232, v232, v109, v110
    s_waitcnt lgkmcnt(5)
    v_mfma_f32_32x32x16_bf16 v[56:71], a[228:231], a[44:47], v[56:71]
    buffer_load_dwordx4 v2, s[24:27], s69 offen offset:0  lds
    v_max3_f32 v233, v233, v117, v118
    v_max3_f32 v234, v234, -v109, -v110
    v_max3_f32 v235, v235, -v117, -v118
    s_waitcnt lgkmcnt(1)
    v_mfma_f32_32x32x16_bf16 v[56:71], a[232:235], a[52:55], v[56:71]
    v_max_f32 v232, v232, v233
    v_max_f32 v234, v234, v235
    s_nop 1
    v_permlane32_swap_b32 v232, v234
    s_waitcnt lgkmcnt(0)
    v_mfma_f32_32x32x16_bf16 v[56:71], a[236:239], a[60:63], v[56:71]
    buffer_load_dwordx4 v3, s[24:27], s69 offen offset:1024  lds
    s_waitcnt vmcnt(10)
    ds_read_b64_tr_b16 a[240:241], v8 offset:2048
    ds_read_b64_tr_b16 a[242:243], v8 offset:2304
    ds_read_b128 a[68:71], v10 offset:49152
    ds_read_b64_tr_b16 a[244:245], v8 offset:9216
    ds_read_b64_tr_b16 a[246:247], v8 offset:9472
    ds_read_b128 a[76:79], v11 offset:49152
    v_max_f32 v232, v232, v234
    v_mul_f32 v232, v36, v232
    v_mov_b32 v234, v232
    ds_read_b64_tr_b16 a[248:249], v8 offset:16384
    buffer_load_dwordx4 v4, s[24:27], s69 offen offset:2048  lds
    ds_read_b64_tr_b16 a[250:251], v8 offset:16640
    ds_read_b128 a[84:87], v12 offset:49152
    ds_read_b64_tr_b16 a[252:253], v8 offset:23552
    ds_read_b64_tr_b16 a[254:255], v8 offset:23808
    ds_read_b128 a[92:95], v13 offset:49152
    v_permlane32_swap_b32 v232, v234
    v_fma_f32 v136, v104, v36, -v232
    v_fma_f32 v137, v105, v36, -v232
    v_fma_f32 v144, v112, v36, -v232
    v_fma_f32 v145, v113, v36, -v232
    v_fma_f32 v152, -v104, v36, -v234
    v_fma_f32 v153, -v105, v36, -v234
    v_fma_f32 v160, -v112, v36, -v234
    v_fma_f32 v161, -v113, v36, -v234
    v_exp_f32_e64 v136, v136
    s_waitcnt lgkmcnt(9)
    v_mfma_f32_32x32x16_bf16 v[56:71], a[240:243], a[68:71], v[56:71]
    buffer_load_dwordx4 v5, s[24:27], s69 offen offset:3072  lds
    s_add_u32 m0, s80, 16384
    s_add_u32 s70, s70, 28672
    v_exp_f32 v137, v137
    s_waitcnt lgkmcnt(6)
    v_mfma_f32_32x32x16_bf16 v[56:71], a[244:247], a[76:79], v[56:71]
    v_fma_f32 v138, v106, v36, -v232
    v_exp_f32 v144, v144
    v_exp_f32 v145, v145
    s_waitcnt lgkmcnt(3)
    v_mfma_f32_32x32x16_bf16 v[56:71], a[248:251], a[84:87], v[56:71]
    buffer_load_dwordx4 v2, s[24:27], s70 offen offset:0  lds
    v_fma_f32 v146, v114, v36, -v232
    v_exp_f32 v152, v152
    s_waitcnt lgkmcnt(0)
    v_mfma_f32_32x32x16_bf16 v[56:71], a[252:255], a[92:95], v[56:71]
    v_exp_f32_e64 v153, v153
    buffer_load_dwordx4 v3, s[24:27], s70 offen offset:1024  lds
    s_waitcnt vmcnt(10)
    ds_read_b64_tr_b16 a[224:225], v8 offset:3072
    ds_read_b64_tr_b16 a[226:227], v8 offset:3328
    ds_read_b128 a[100:103], v14 offset:0
    ds_read_b64_tr_b16 a[228:229], v8 offset:10240
    ds_read_b64_tr_b16 a[230:231], v8 offset:10496
    ds_read_b128 a[108:111], v15 offset:0
    v_fma_f32 v154, -v106, v36, -v234
    v_exp_f32_e64 v160, v160
    ds_read_b64_tr_b16 a[232:233], v8 offset:17408
    buffer_load_dwordx4 v4, s[24:27], s70 offen offset:2048  lds
    ds_read_b64_tr_b16 a[234:235], v8 offset:17664
    ds_read_b128 a[116:119], v16 offset:0
    ds_read_b64_tr_b16 a[236:237], v8 offset:24576
    ds_read_b64_tr_b16 a[238:239], v8 offset:24832
    ds_read_b128 a[124:127], v17 offset:0
    v_exp_f32 v161, v161
    v_fma_f32 v162, -v114, v36, -v234
    v_exp_f32 v138, v138
    v_fma_f32 v139, v107, v36, -v232
    v_exp_f32 v146, v146
    v_fma_f32 v147, v115, v36, -v232
    v_exp_f32 v154, v154
    v_fma_f32 v155, -v107, v36, -v234
    s_waitcnt lgkmcnt(9)
    v_mfma_f32_32x32x16_bf16 v[56:71], a[224:227], a[100:103], v[56:71]
    buffer_load_dwordx4 v5, s[24:27], s70 offen offset:3072  lds
    s_add_u32 m0, s3, 126976
    v_exp_f32 v162, v162
    s_waitcnt lgkmcnt(6)
    v_mfma_f32_32x32x16_bf16 v[56:71], a[228:231], a[108:111], v[56:71]
    v_fma_f32 v163, -v115, v36, -v234
    v_exp_f32 v139, v139
    v_fma_f32 v140, v108, v36, -v232
    v_exp_f32 v147, v147
    s_waitcnt lgkmcnt(3)
    v_mfma_f32_32x32x16_bf16 v[56:71], a[232:235], a[116:119], v[56:71]
    buffer_load_dwordx4 v251, s[28:31], s72 offen offset:0  lds
    v_fma_f32 v148, v116, v36, -v232
    v_exp_f32_e64 v155, v155
    s_waitcnt lgkmcnt(0)
    v_mfma_f32_32x32x16_bf16 v[56:71], a[236:239], a[124:127], v[56:71]
    v_fma_f32 v156, -v108, v36, -v234
    s_waitcnt vmcnt(9)
    ds_read_b64_tr_b16 a[240:241], v8 offset:4096
    buffer_load_dwordx4 v251, s[28:31], s73 offen offset:1024  lds
    ds_read_b64_tr_b16 a[242:243], v8 offset:4352
    ds_read_b128 a[132:135], v14 offset:16384
    ds_read_b64_tr_b16 a[244:245], v8 offset:11264
    ds_read_b64_tr_b16 a[246:247], v8 offset:11520
    ds_read_b128 a[140:143], v15 offset:16384
    v_exp_f32_e64 v163, v163
    v_fma_f32 v164, -v116, v36, -v234
    ds_read_b64_tr_b16 a[248:249], v8 offset:18432
    ds_read_b64_tr_b16 a[250:251], v8 offset:18688
    ds_read_b128 a[148:151], v16 offset:16384
    v_exp_f32_e64 v140, v140
    buffer_load_dwordx4 v251, s[28:31], s74 offen offset:2048  lds
    ds_read_b64_tr_b16 a[252:253], v8 offset:25600
    ds_read_b64_tr_b16 a[254:255], v8 offset:25856
    ds_read_b128 a[156:159], v17 offset:16384
    v_fma_f32 v141, v109, v36, -v232
    v_exp_f32 v148, v148
    v_fma_f32 v149, v117, v36, -v232
    v_exp_f32 v156, v156
    v_fma_f32 v157, -v109, v36, -v234
    v_exp_f32 v164, v164
    v_fma_f32 v165, -v117, v36, -v234
    v_add_f32 v236, v136, v137
    v_add_f32 v237, v144, v145
    s_waitcnt lgkmcnt(9)
    v_mfma_f32_32x32x16_bf16 v[56:71], a[240:243], a[132:135], v[56:71]
    buffer_load_dwordx4 v251, s[28:31], s75 offen offset:3072  lds
    s_add_u32 m0, s3, 131072
    v_add_f32 v238, v152, v153
    v_add_f32 v239, v160, v161
    s_waitcnt lgkmcnt(6)
    v_mfma_f32_32x32x16_bf16 v[56:71], a[244:247], a[140:143], v[56:71]
    v_exp_f32 v141, v141
    v_fma_f32 v142, v110, v36, -v232
    v_exp_f32 v149, v149
    s_waitcnt lgkmcnt(3)
    v_mfma_f32_32x32x16_bf16 v[56:71], a[248:251], a[148:151], v[56:71]
    v_fma_f32 v150, v118, v36, -v232
    v_exp_f32 v157, v157
    v_fma_f32 v158, -v110, v36, -v234
    v_exp_f32 v165, v165
    s_waitcnt lgkmcnt(0)
    v_mfma_f32_32x32x16_bf16 v[56:71], a[252:255], a[156:159], v[56:71]
    v_fma_f32 v166, -v118, v36, -v234
    v_add_f32 v236, v236, v138
    v_add_f32 v237, v237, v146
    v_add_f32_e64 v238, v238, v154
    s_waitcnt vmcnt(8)
    ds_read_b64_tr_b16 a[224:225], v8 offset:5120
    ds_read_b64_tr_b16 a[226:227], v8 offset:5376
    ds_read_b128 a[164:167], v10 offset:0
    ds_read_b64_tr_b16 a[228:229], v8 offset:12288
    ds_read_b64_tr_b16 a[230:231], v8 offset:12544
    buffer_load_dwordx4 v251, s[28:31], s76 offen offset:0  lds
    ds_read_b128 a[172:175], v11 offset:0
    v_add_f32 v239, v239, v162
    v_exp_f32 v142, v142
    ds_read_b64_tr_b16 a[232:233], v8 offset:19456
    ds_read_b64_tr_b16 a[234:235], v8 offset:19712
    ds_read_b128 a[180:183], v12 offset:0
    v_exp_f32 v150, v150
    ds_read_b64_tr_b16 a[236:237], v8 offset:26624
    ds_read_b64_tr_b16 a[238:239], v8 offset:26880
    ds_read_b128 a[188:191], v13 offset:0
    v_exp_f32 v158, v158
    v_exp_f32 v166, v166
    v_add_f32 v236, v236, v139
    v_add_f32 v237, v237, v147
    v_add_f32 v238, v238, v155
    v_add_f32 v239, v239, v163
    v_add_f32 v236, v236, v140
    v_add_f32 v237, v237, v148
    v_add_f32 v238, v238, v156
    v_add_f32 v239, v239, v164
    s_waitcnt lgkmcnt(9)
    v_mfma_f32_32x32x16_bf16 v[56:71], a[224:227], a[164:167], v[56:71]
    v_add_f32 v236, v236, v141
    v_add_f32 v237, v237, v149
    v_add_f32 v238, v238, v157
    v_add_f32 v239, v239, v165
    v_add_f32 v236, v236, v142
    s_waitcnt lgkmcnt(6)
    v_mfma_f32_32x32x16_bf16 v[56:71], a[228:231], a[172:175], v[56:71]
    v_add_f32 v237, v237, v150
    v_add_f32 v238, v238, v158
    v_add_f32 v239, v239, v166
    v_add_f32 v236, v236, v237
    v_add_f32 v238, v238, v239
    s_waitcnt lgkmcnt(0)
    v_mfma_f32_32x32x16_bf16 v[56:71], a[232:235], a[180:183], v[56:71]
    v_permlane32_swap_b32 v236, v238
    v_add_f32 v236, v236, v238
    v_rcp_f32 v236, v236
    v_mfma_f32_32x32x16_bf16 v[56:71], a[236:239], a[188:191], v[56:71]
    buffer_load_dwordx4 v251, s[28:31], s77 offen offset:1024  lds
    v_mov_b32 v238, v236
    v_mov_b32 v17, 0x3f803f80
    v_mov_b32 v2, 0xffff
    v_permlane32_swap_b32 v236, v238
    s_waitcnt vmcnt(6)
    ds_read_b64_tr_b16 a[240:241], v8 offset:6144
    ds_read_b64_tr_b16 a[242:243], v8 offset:6400
    ds_read_b128 a[196:199], v10 offset:16384
    ds_read_b64_tr_b16 a[244:245], v8 offset:13312
    ds_read_b64_tr_b16 a[246:247], v8 offset:13568
    ds_read_b128 a[204:207], v11 offset:16384
    v_mul_f32 v136, v136, v236
    v_mul_f32 v137, v137, v236
    v_mul_f32 v152, v152, v238
    ds_read_b64_tr_b16 a[248:249], v8 offset:20480
    ds_read_b64_tr_b16 a[250:251], v8 offset:20736
    ds_read_b128 a[212:215], v12 offset:16384
    v_mul_f32 v153, v153, v238
    v_cvt_pk_bf16_f32 v136, v136, v137
    v_mul_f32 v138, v138, v236
    ds_read_b64_tr_b16 a[252:253], v8 offset:27648
    ds_read_b64_tr_b16 a[254:255], v8 offset:27904
    ds_read_b128 a[220:223], v13 offset:16384
    v_mul_f32 v139, v139, v236
    v_cvt_pk_bf16_f32 v152, v152, v153
    v_mul_f32 v154, v154, v238
    v_mul_f32 v155, v155, v238
    v_cvt_pk_bf16_f32 v137, v138, v139
    v_mul_f32 v140, v140, v236
    v_mul_f32 v141, v141, v236
    v_mul_f32 v142, v142, v236
    v_cvt_pk_bf16_f32 v153, v154, v155
    v_mul_f32 v156, v156, v238
    v_mul_f32 v157, v157, v238
    v_mul_f32 v158, v158, v238
    s_waitcnt lgkmcnt(6)
    v_mfma_f32_32x32x16_bf16 v[56:71], a[240:243], a[196:199], v[56:71]
    buffer_load_dwordx4 v251, s[28:31], s78 offen offset:2048  lds
    s_add_u32 m0, s3, 0
    v_cvt_pk_bf16_f32 v138, v140, v141
    v_cvt_pk_bf16_f32 v139, v142, 0
    v_mfma_f32_32x32x16_bf16 v[56:71], a[244:247], a[204:207], v[56:71]
    v_cvt_pk_bf16_f32 v154, v156, v157
    v_cvt_pk_bf16_f32 v155, v158, 0
    v_mul_f32 v144, v144, v236
    v_mul_f32 v145, v145, v236
    v_mul_f32 v146, v146, v236
    s_waitcnt lgkmcnt(0)
    v_mfma_f32_32x32x16_bf16 v[56:71], a[248:251], a[212:215], v[56:71]
    v_mul_f32_e64 v147, v147, v236
    s_waitcnt vmcnt(6)
    s_barrier
    ds_read_b64_tr_b16 a[224:225], v8 offset:28672
    v_mfma_f32_32x32x16_bf16 v[56:71], a[252:255], a[220:223], v[56:71]
    ds_read_b64_tr_b16 a[226:227], v8 offset:28928
    ds_read_b64_tr_b16 a[228:229], v8 offset:35840
    ds_read_b64_tr_b16 a[230:231], v8 offset:36096
    ds_read_b64_tr_b16 a[232:233], v8 offset:43008
    ds_read_b64_tr_b16 a[234:235], v8 offset:43264
    v_mfma_f32_32x32x16_bf16 v[104:119], v[136:139], v[28:31], 0
    ds_read_b64_tr_b16 a[236:237], v8 offset:50176
    ds_read_b64_tr_b16 a[238:239], v8 offset:50432
    v_mul_f32 v148, v148, v236
    v_mul_f32_e64 v149, v149, v236
    s_nop 1
    v_cvt_pk_bf16_f32 v56, v56, v57
    v_cvt_pk_bf16_f32 v57, v58, v59
    v_mfma_f32_32x32x16_bf16 v[40:55], v[152:155], v[28:31], 0
    v_cvt_pk_bf16_f32 v58, v60, v61
    v_cvt_pk_bf16_f32 v59, v62, v63
    v_cvt_pk_bf16_f32 v62, v68, v69
    v_cvt_pk_bf16_f32 v63, v70, v71
    v_cvt_pk_bf16_f32 v60, v64, v65
    v_cvt_pk_bf16_f32 v61, v66, v67
    v_mfma_f32_32x32x16_bf16 v[120:135], v[20:23], v[56:59], 0
    buffer_load_dwordx4 v253, s[28:31], s72 offen offset:0  lds
    v_cndmask_b32_e64 v62, v62, 0, s[60:61]
    v_cndmask_b32_e64 v63, v63, 0, s[60:61]
    v_mul_f32 v150, v150, v236
    v_mul_f32 v160, v160, v238
    v_mfma_f32_32x32x16_bf16 v[120:135], v[24:27], v[60:63], v[120:135]
    v_mul_f32 v161, v161, v238
    v_mul_f32 v162, v162, v238
    v_mul_f32 v163, v163, v238
    s_waitcnt vmcnt(6)
    s_barrier
    ds_read_b64_tr_b16 a[240:241], v8 offset:29696
    s_waitcnt lgkmcnt(1)
    v_mfma_f32_32x32x16_bf16 v[72:87], a[0:3], a[224:227], 0
    ds_read_b64_tr_b16 a[242:243], v8 offset:29952
    ds_read_b64_tr_b16 a[244:245], v8 offset:36864
    ds_read_b64_tr_b16 a[246:247], v8 offset:37120
    ds_read_b64_tr_b16 a[248:249], v8 offset:44032
    ds_read_b64_tr_b16 a[250:251], v8 offset:44288
    v_mfma_f32_32x32x16_bf16 v[72:87], a[8:11], a[228:231], v[72:87]
    ds_read_b64_tr_b16 a[252:253], v8 offset:51200
    ds_read_b64_tr_b16 a[254:255], v8 offset:51456
    v_mul_f32 v164, v164, v238
    v_mul_f32 v165, v165, v238
    v_mul_f32_e64 v166, v166, v238
    v_mfma_f32_32x32x16_bf16 v[88:103], a[4:7], a[224:227], 0
    v_cvt_pk_bf16_f32 v140, v144, v145
    v_cvt_pk_bf16_f32 v141, v146, v147
    v_cvt_pk_bf16_f32 v142, v148, v149
    v_cvt_pk_bf16_f32 v143, v150, 0
    v_cvt_pk_bf16_f32 v156, v160, v161
    v_cvt_pk_bf16_f32 v157, v162, v163
    v_mfma_f32_32x32x16_bf16 v[104:119], v[140:143], v[32:35], v[104:119]
    v_cvt_pk_bf16_f32 v158, v164, v165
    v_cvt_pk_bf16_f32 v159, v166, 0
    v_max3_f32 v240, v120, v121, v122
    v_max3_f32 v241, v128, v129, v130
    v_max3_f32 v242, -v120, -v121, -v122
    v_max3_f32 v243, -v128, -v129, -v130
    v_mfma_f32_32x32x16_bf16 v[40:55], v[156:159], v[32:35], v[40:55]
    buffer_load_dwordx4 v253, s[28:31], s73 offen offset:1024  lds
    v_max3_f32 v240, v240, v123, v124
    v_max3_f32 v241, v241, v131, v132
    v_max3_f32 v242, v242, -v123, -v124
    v_max3_f32 v243, v243, -v131, -v132
    v_mfma_f32_32x32x16_bf16 v[72:87], a[16:19], a[232:235], v[72:87]
    v_max3_f32 v240, v240, v125, v126
    v_max3_f32 v241, v241, v133, v134
    v_max3_f32 v242, v242, -v125, -v126
    v_max3_f32 v243, v243, -v133, -v134
    s_waitcnt vmcnt(6)
    v_mfma_f32_32x32x16_bf16 v[88:103], a[12:15], a[228:231], v[88:103]
    s_barrier
    ds_read_b64_tr_b16 a[224:225], v8 offset:30720
    ds_read_b64_tr_b16 a[226:227], v8 offset:30976
    ds_read_b64_tr_b16 a[228:229], v8 offset:37888
    ds_read_b64_tr_b16 a[230:231], v8 offset:38144
    v_max_f32 v240, v240, v241
    v_mfma_f32_32x32x16_bf16 v[72:87], a[24:27], a[236:239], v[72:87]
    v_max_f32 v242, v242, v243
    v_cvt_pk_bf16_f32 v40, v40, v41
    v_cvt_pk_bf16_f32 v41, v42, v43
    v_permlane32_swap_b32 v240, v242
    v_mfma_f32_32x32x16_bf16 v[88:103], a[20:23], a[232:235], v[88:103]
    ds_read_b64_tr_b16 a[232:233], v8 offset:45056
    ds_read_b64_tr_b16 a[234:235], v8 offset:45312
    v_max_f32 v240, v240, v242
    v_mul_f32 v240, v36, v240
    v_mov_b32 v242, v240
    v_cvt_pk_bf16_f32 v42, v44, v45
    s_waitcnt lgkmcnt(6)
    v_mfma_f32_32x32x16_bf16 v[72:87], a[32:35], a[240:243], v[72:87]
    v_permlane32_swap_b32 v240, v242
    v_fma_f32 v168, v120, v36, -v240
    v_fma_f32 v169, v121, v36, -v240
    v_fma_f32 v176, v128, v36, -v240
    v_mfma_f32_32x32x16_bf16 v[88:103], a[28:31], a[236:239], v[88:103]
    ds_read_b64_tr_b16 a[236:237], v8 offset:52224
    buffer_load_dwordx4 v253, s[28:31], s74 offen offset:2048  lds
    ds_read_b64_tr_b16 a[238:239], v8 offset:52480
    v_fma_f32 v177, v129, v36, -v240
    v_fma_f32 v184, -v120, v36, -v242
    v_mfma_f32_32x32x16_bf16 v[72:87], a[40:43], a[244:247], v[72:87]
    v_fma_f32 v185, -v121, v36, -v242
    v_fma_f32 v192, -v128, v36, -v242
    v_fma_f32 v193, -v129, v36, -v242
    v_exp_f32 v168, v168
    v_mfma_f32_32x32x16_bf16 v[88:103], a[36:39], a[240:243], v[88:103]
    v_exp_f32 v169, v169
    v_fma_f32 v170, v122, v36, -v240
    v_exp_f32 v176, v176
    v_exp_f32 v177, v177
    v_mfma_f32_32x32x16_bf16 v[72:87], a[48:51], a[248:251], v[72:87]
    v_fma_f32 v178, v130, v36, -v240
    v_exp_f32 v184, v184
    v_exp_f32 v185, v185
    v_mfma_f32_32x32x16_bf16 v[88:103], a[44:47], a[244:247], v[88:103]
    v_fma_f32 v186, -v122, v36, -v242
    v_exp_f32 v192, v192
    v_exp_f32 v193, v193
    v_fma_f32 v194, -v130, v36, -v242
    v_mfma_f32_32x32x16_bf16 v[72:87], a[56:59], a[252:255], v[72:87]
    v_exp_f32 v170, v170
    v_fma_f32 v171, v123, v36, -v240
    v_exp_f32 v178, v178
    v_mfma_f32_32x32x16_bf16 v[88:103], a[52:55], a[248:251], v[88:103]
    v_fma_f32 v179, v131, v36, -v240
    v_exp_f32 v186, v186
    v_fma_f32 v187, -v123, v36, -v242
    v_exp_f32_e64 v194, v194
    s_waitcnt lgkmcnt(0)
    v_mfma_f32_32x32x16_bf16 v[72:87], a[64:67], a[224:227], v[72:87]
    buffer_load_dwordx4 v253, s[28:31], s75 offen offset:3072  lds
    s_add_u32 m0, s3, 4096
    v_fma_f32 v195, -v131, v36, -v242
    v_exp_f32_e64 v171, v171
    v_mfma_f32_32x32x16_bf16 v[88:103], a[60:63], a[252:255], v[88:103]
    s_waitcnt vmcnt(6)
    s_barrier
    ds_read_b64_tr_b16 a[240:241], v8 offset:31744
    ds_read_b64_tr_b16 a[242:243], v8 offset:32000
    ds_read_b64_tr_b16 a[244:245], v8 offset:38912
    ds_read_b64_tr_b16 a[246:247], v8 offset:39168
    v_mfma_f32_32x32x16_bf16 v[72:87], a[72:75], a[228:231], v[72:87]
    ds_read_b64_tr_b16 a[248:249], v8 offset:46080
    ds_read_b64_tr_b16 a[250:251], v8 offset:46336
    ds_read_b64_tr_b16 a[252:253], v8 offset:53248
    ds_read_b64_tr_b16 a[254:255], v8 offset:53504
    v_fma_f32 v172, v124, v36, -v240
    v_mfma_f32_32x32x16_bf16 v[88:103], a[68:71], a[224:227], v[88:103]
    ds_read_b64_tr_b16 a[224:225], v8 offset:32768
    ds_read_b64_tr_b16 a[226:227], v8 offset:33024
    v_exp_f32 v179, v179
    v_fma_f32 v180, v132, v36, -v240
    v_exp_f32 v187, v187
    v_mfma_f32_32x32x16_bf16 v[72:87], a[80:83], a[232:235], v[72:87]
    v_fma_f32 v188, -v124, v36, -v242
    v_exp_f32 v195, v195
    v_fma_f32 v196, -v132, v36, -v242
    v_exp_f32 v172, v172
    v_mfma_f32_32x32x16_bf16 v[88:103], a[76:79], a[228:231], v[88:103]
    buffer_load_dwordx4 v253, s[28:31], s76 offen offset:0  lds
    ds_read_b64_tr_b16 a[228:229], v8 offset:39936
    ds_read_b64_tr_b16 a[230:231], v8 offset:40192
    v_fma_f32 v173, v125, v36, -v240
    v_exp_f32 v180, v180
    v_mfma_f32_32x32x16_bf16 v[72:87], a[88:91], a[236:239], v[72:87]
    v_fma_f32 v181, v133, v36, -v240
    v_exp_f32 v188, v188
    v_fma_f32 v189, -v125, v36, -v242
    v_exp_f32_e64 v196, v196
    v_mfma_f32_32x32x16_bf16 v[88:103], a[84:87], a[232:235], v[88:103]
    ds_read_b64_tr_b16 a[232:233], v8 offset:47104
    ds_read_b64_tr_b16 a[234:235], v8 offset:47360
    v_fma_f32 v197, -v133, v36, -v242
    v_add_f32 v244, v168, v169
    v_add_f32 v245, v176, v177
    v_add_f32 v246, v184, v185
    s_waitcnt lgkmcnt(4)
    v_mfma_f32_32x32x16_bf16 v[72:87], a[96:99], a[240:243], v[72:87]
    v_add_f32 v247, v192, v193
    v_exp_f32 v173, v173
    v_fma_f32 v174, v126, v36, -v240
    v_exp_f32_e64 v181, v181
    v_mfma_f32_32x32x16_bf16 v[88:103], a[92:95], a[236:239], v[88:103]
    ds_read_b64_tr_b16 a[236:237], v8 offset:54272
    ds_read_b64_tr_b16 a[238:239], v8 offset:54528
    v_fma_f32 v182, v134, v36, -v240
    v_exp_f32 v189, v189
    v_fma_f32 v190, -v126, v36, -v242
    v_mfma_f32_32x32x16_bf16 v[72:87], a[104:107], a[244:247], v[72:87]
    v_exp_f32 v197, v197
    v_fma_f32 v198, -v134, v36, -v242
    v_add_f32 v244, v244, v170
    v_add_f32 v245, v245, v178
    v_mfma_f32_32x32x16_bf16 v[88:103], a[100:103], a[240:243], v[88:103]
    buffer_load_dwordx4 v253, s[28:31], s77 offen offset:1024  lds
    v_add_f32 v246, v246, v186
    v_add_f32 v247, v247, v194
    v_exp_f32 v174, v174
    v_mfma_f32_32x32x16_bf16 v[72:87], a[112:115], a[248:251], v[72:87]
    v_exp_f32 v182, v182
    v_exp_f32_e64 v190, v190
    s_waitcnt vmcnt(6)
    v_mfma_f32_32x32x16_bf16 v[88:103], a[108:111], a[244:247], v[88:103]
    s_barrier
    ds_read_b64_tr_b16 a[240:241], v8 offset:33792
    ds_read_b64_tr_b16 a[242:243], v8 offset:34048
    ds_read_b64_tr_b16 a[244:245], v8 offset:40960
    ds_read_b64_tr_b16 a[246:247], v8 offset:41216
    v_exp_f32 v198, v198
    v_mfma_f32_32x32x16_bf16 v[72:87], a[120:123], a[252:255], v[72:87]
    v_add_f32 v244, v244, v171
    v_add_f32 v245, v245, v179
    v_add_f32 v246, v246, v187
    v_add_f32 v247, v247, v195
    v_add_f32 v244, v244, v172
    v_mfma_f32_32x32x16_bf16 v[88:103], a[116:119], a[248:251], v[88:103]
    ds_read_b64_tr_b16 a[248:249], v8 offset:48128
    ds_read_b64_tr_b16 a[250:251], v8 offset:48384
    v_add_f32 v245, v245, v180
    v_add_f32 v246, v246, v188
    v_add_f32 v247, v247, v196
    v_add_f32 v244, v244, v173
    v_mfma_f32_32x32x16_bf16 v[72:87], a[128:131], a[224:227], v[72:87]
    v_add_f32 v245, v245, v181
    v_add_f32 v246, v246, v189
    v_add_f32 v247, v247, v197
    v_add_f32 v244, v244, v174
    v_add_f32_e64 v245, v245, v182
    v_mfma_f32_32x32x16_bf16 v[88:103], a[124:127], a[252:255], v[88:103]
    buffer_load_dwordx4 v253, s[28:31], s78 offen offset:2048  lds
    ds_read_b64_tr_b16 a[252:253], v8 offset:55296
    ds_read_b64_tr_b16 a[254:255], v8 offset:55552
    v_add_f32 v246, v246, v190
    v_add_f32 v247, v247, v198
    s_waitcnt lgkmcnt(4)
    v_mfma_f32_32x32x16_bf16 v[72:87], a[136:139], a[228:231], v[72:87]
    v_add_f32 v244, v244, v245
    v_add_f32 v246, v246, v247
    v_cvt_pk_bf16_f32 v43, v46, v47
    v_cvt_pk_bf16_f32 v44, v48, v49
    v_permlane32_swap_b32 v244, v246
    v_mfma_f32_32x32x16_bf16 v[88:103], a[132:135], a[224:227], v[88:103]
    ds_read_b64_tr_b16 a[224:225], v8 offset:34816
    ds_read_b64_tr_b16 a[226:227], v8 offset:35072
    v_add_f32 v244, v244, v246
    v_rcp_f32 v244, v244
    v_cvt_pk_bf16_f32 v45, v50, v51
    v_mfma_f32_32x32x16_bf16 v[72:87], a[144:147], a[232:235], v[72:87]
    v_mov_b32 v246, v244
    v_cvt_pk_bf16_f32 v46, v52, v53
    v_cvt_pk_bf16_f32 v47, v54, v55
    v_permlane32_swap_b32 v244, v246
    v_mfma_f32_32x32x16_bf16 v[88:103], a[140:143], a[228:231], v[88:103]
    ds_read_b64_tr_b16 a[228:229], v8 offset:41984
    ds_read_b64_tr_b16 a[230:231], v8 offset:42240
    v_mul_f32 v184, v184, v246
    v_mul_f32 v185, v185, v246
    v_cvt_pk_bf16_f32 v184, v184, v185
    v_mul_f32 v186, v186, v246
    v_mfma_f32_32x32x16_bf16 v[72:87], a[152:155], a[236:239], v[72:87]
    v_mul_f32 v187, v187, v246
    v_cvt_pk_bf16_f32 v185, v186, v187
    v_mul_f32 v188, v188, v246
    v_mul_f32 v189, v189, v246
    v_mul_f32_e64 v190, v190, v246
    v_mfma_f32_32x32x16_bf16 v[88:103], a[148:151], a[232:235], v[88:103]
    buffer_load_dword v18, v254, s[32:35], 0 offen
    ds_read_b64_tr_b16 a[232:233], v8 offset:49152
    ds_read_b64_tr_b16 a[234:235], v8 offset:49408
    v_cvt_pk_bf16_f32 v186, v188, v189
    v_cvt_pk_bf16_f32 v187, v190, 0
    v_mfma_f32_32x32x16_bf16 v[72:87], a[160:163], a[240:243], v[72:87]
    v_mul_f32 v192, v192, v246
    v_mul_f32 v193, v193, v246
    v_mul_f32 v194, v194, v246
    v_mul_f32 v195, v195, v246
    v_mul_f32 v196, v196, v246
    v_mfma_f32_32x32x16_bf16 v[88:103], a[156:159], a[236:239], v[88:103]
    ds_read_b64_tr_b16 a[236:237], v8 offset:56320
    ds_read_b64_tr_b16 a[238:239], v8 offset:56576
    v_mul_f32 v197, v197, v246
    v_mul_f32_e64 v198, v198, v246
    v_cvt_pk_bf16_f32 v188, v192, v193
    v_cvt_pk_bf16_f32 v189, v194, v195
    v_mfma_f32_32x32x16_bf16 v[72:87], a[168:171], a[244:247], v[72:87]
    v_cvt_pk_bf16_f32 v190, v196, v197
    v_cvt_pk_bf16_f32 v191, v198, 0
    v_mul_f32 v168, v168, v244
    v_mul_f32 v169, v169, v244
    v_cvt_pk_bf16_f32 v168, v168, v169
    v_mfma_f32_32x32x16_bf16 v[88:103], a[164:167], a[240:243], v[88:103]
    v_mul_f32 v170, v170, v244
    v_mul_f32 v171, v171, v244
    v_cvt_pk_bf16_f32 v169, v170, v171
    v_mul_f32 v172, v172, v244
    v_mul_f32 v173, v173, v244
    v_mul_f32 v174, v174, v244
    s_waitcnt lgkmcnt(2)
    v_mfma_f32_32x32x16_bf16 v[72:87], a[176:179], a[248:251], v[72:87]
    v_add_u32 v10, s9, v249
    v_cvt_pk_bf16_f32 v170, v172, v173
    v_cvt_pk_bf16_f32 v171, v174, 0
    v_mul_f32 v176, v176, v244
    v_mul_f32 v177, v177, v244
    v_mfma_f32_32x32x16_bf16 v[88:103], a[172:175], a[244:247], v[88:103]
    v_mul_f32 v178, v178, v244
    v_mul_f32 v179, v179, v244
    v_mul_f32 v180, v180, v244
    v_mul_f32 v181, v181, v244
    v_mul_f32 v182, v182, v244
    v_cvt_pk_bf16_f32 v172, v176, v177
    v_mfma_f32_32x32x16_bf16 v[72:87], a[184:187], a[252:255], v[72:87]
    buffer_load_dword v18, v255, s[40:43], s96 offen sc1
    v_cvt_pk_bf16_f32 v173, v178, v179
    v_cvt_pk_bf16_f32 v174, v180, v181
    v_cvt_pk_bf16_f32 v175, v182, 0
    v_mfma_f32_32x32x16_bf16 v[88:103], a[180:183], a[248:251], v[88:103]
    v_cvt_pk_bf16_f32 v104, v104, v105
    v_cvt_pk_bf16_f32 v105, v106, v107
    v_cvt_pk_bf16_f32 v106, v108, v109
    v_cvt_pk_bf16_f32 v107, v110, v111
    v_cvt_pk_bf16_f32 v108, v112, v113
    v_cvt_pk_bf16_f32 v109, v114, v115
    v_mfma_f32_32x32x16_bf16 v[72:87], a[192:195], a[224:227], v[72:87]
    v_cvt_pk_bf16_f32 v110, v116, v117
    v_cvt_pk_bf16_f32 v111, v118, v119
    v_xor_b32 v11, 4096, v10
    v_xor_b32 v12, 8192, v10
    v_xor_b32 v13, 12288, v10
    v_mfma_f32_32x32x16_bf16 v[88:103], a[188:191], a[252:255], v[88:103]
    v_mfma_f32_32x32x16_bf16 v[72:87], a[200:203], a[228:231], v[72:87]
    v_mfma_f32_32x32x16_bf16 v[88:103], a[196:199], a[224:227], v[88:103]
    buffer_load_dword v18, v9, s[40:43], s53 offen sc1
    v_mfma_f32_32x32x16_bf16 v[72:87], a[208:211], a[232:235], v[72:87]
    v_mfma_f32_32x32x16_bf16 v[88:103], a[204:207], a[228:231], v[88:103]
    s_waitcnt lgkmcnt(0)
    v_mfma_f32_32x32x16_bf16 v[72:87], a[216:219], a[236:239], v[72:87]
    v_mfma_f32_32x32x16_bf16 v[88:103], a[212:215], a[232:235], v[88:103]
    s_nop 10
    v_cvt_pk_bf16_f32 v72, v72, v73
    v_cvt_pk_bf16_f32 v73, v74, v75
    v_mfma_f32_32x32x16_bf16 v[56:71], v[184:187], v[28:31], 0
    v_cvt_pk_bf16_f32 v74, v76, v77
    v_cvt_pk_bf16_f32 v75, v78, v79
    v_cndmask_b32_e64 v72, v72, v17, s[62:63]
    v_cndmask_b32_e64 v73, v73, v17, s[62:63]
    v_cndmask_b32_e64 v74, v74, v17, s[62:63]
    v_cndmask_b32_e64 v75, v75, v17, s[62:63]
    v_mfma_f32_32x32x16_bf16 v[88:103], a[220:223], a[236:239], v[88:103]
    v_cvt_pk_bf16_f32 v76, v80, v81
    v_cvt_pk_bf16_f32 v77, v82, v83
    v_cvt_pk_bf16_f32 v78, v84, v85
    v_cvt_pk_bf16_f32 v79, v86, v87
    v_cndmask_b32_e64 v76, v76, v17, s[62:63]
    v_cndmask_b32_e64 v77, v77, v17, s[62:63]
    v_mfma_f32_32x32x16_bf16 v[56:71], v[188:191], v[32:35], v[56:71]
    buffer_store_dwordx2 v[38:39], v19, s[40:43], s79 offen sc1
    v_cndmask_b32_e64 v78, v78, v17, s[62:63]
    v_cndmask_b32_e64 v79, v79, v17, s[62:63]
    s_nop 1
    v_cvt_pk_bf16_f32 v88, v88, v89
    v_cvt_pk_bf16_f32 v89, v90, v91
    v_mfma_f32_32x32x16_bf16 v[216:231], v[40:43], v[72:75], 0
    v_cvt_pk_bf16_f32 v90, v92, v93
    v_cvt_pk_bf16_f32 v91, v94, v95
    v_cndmask_b32_e64 v88, v88, v17, s[62:63]
    v_cndmask_b32_e64 v89, v89, v17, s[62:63]
    v_cvt_pk_bf16_f32 v56, v56, v57
    v_cvt_pk_bf16_f32 v57, v58, v59
    v_mfma_f32_32x32x16_bf16 v[216:231], v[44:47], v[76:79], v[216:231]
    v_cvt_pk_bf16_f32 v58, v60, v61
    v_cvt_pk_bf16_f32 v59, v62, v63
    v_cndmask_b32_e64 v90, v90, v17, s[62:63]
    v_cndmask_b32_e64 v91, v91, v17, s[62:63]
    v_cvt_pk_bf16_f32 v92, v96, v97
    v_cvt_pk_bf16_f32 v93, v98, v99
    v_mfma_f32_32x32x16_bf16 v[216:231], v[56:59], v[88:91], v[216:231]
    v_cvt_pk_bf16_f32 v94, v100, v101
    v_cvt_pk_bf16_f32 v95, v102, v103
    v_cvt_pk_bf16_f32 v60, v64, v65
    v_cvt_pk_bf16_f32 v61, v66, v67
    v_cvt_pk_bf16_f32 v62, v68, v69
    v_cvt_pk_bf16_f32 v63, v70, v71
    v_mfma_f32_32x32x16_bf16 v[120:135], v[168:171], v[28:31], 0
    v_cndmask_b32_e64 v92, v92, v17, s[62:63]
    v_cndmask_b32_e64 v93, v93, v17, s[62:63]
    v_cndmask_b32_e64 v94, v94, v17, s[62:63]
    v_cndmask_b32_e64 v95, v95, v17, s[62:63]
    s_nop 1
    v_mfma_f32_32x32x16_bf16 v[216:231], v[60:63], v[92:95], v[216:231]
    v_mfma_f32_32x32x16_bf16 v[120:135], v[172:175], v[32:35], v[120:135]
    s_nop 10
    ds_write_b128 v10, v[216:219] offset:16384
    v_mfma_f32_32x32x16_bf16 v[200:215], v[104:107], v[72:75], 0
    v_cvt_pk_bf16_f32 v120, v120, v121
    v_cvt_pk_bf16_f32 v121, v122, v123
    v_cvt_pk_bf16_f32 v122, v124, v125
    v_cvt_pk_bf16_f32 v123, v126, v127
    v_cvt_pk_bf16_f32 v124, v128, v129
    v_mfma_f32_32x32x16_bf16 v[200:215], v[108:111], v[76:79], v[200:215]
    ds_write_b128 v10, v[220:223] offset:17408
    v_cvt_pk_bf16_f32 v125, v130, v131
    v_mfma_f32_32x32x16_bf16 v[200:215], v[120:123], v[88:91], v[200:215]
    v_cvt_pk_bf16_f32 v126, v132, v133
    v_cvt_pk_bf16_f32 v127, v134, v135
    ds_write_b128 v10, v[224:227] offset:18432
    s_nop 0
    v_mfma_f32_32x32x16_bf16 v[200:215], v[124:127], v[92:95], v[200:215]
    ds_write_b128 v10, v[228:231] offset:19456
    s_nop 10
    ds_write_b128 v10, v[208:211] offset:2048
    ds_write_b128 v10, v[212:215] offset:3072
    s_getpc_b64 s[24:25]
L_pcB:
    s_add_u32 s24, s24, L_tab - L_pcB
    s_addc_u32 s25, s25, 0
    s_waitcnt lgkmcnt(0)
    s_waitcnt vmcnt(9)
    s_barrier
    ds_read_b128 v[80:83], v11 offset:2048
    ds_read_b128 v[84:87], v11 offset:3072
    ds_read_b128 v[88:91], v12 offset:16384
    s_mul_i32 s57, s51, 14336
    s_lshl_b32 s86, s83, 8
    ds_read_b128 v[92:95], v12 offset:17408
    s_add_u32 s57, s57, s86
    v_add_u32 v3, 2560, v252
    v_xor_b32_e64 v5, 32, v252
    ds_read_b128 v[96:99], v13 offset:18432
    ds_read_b128 v[100:103], v13 offset:19456
    v_add_u32 v4, 5120, v5
    v_add_u32 v5, 7680, v5
    v_and_b32 v13, 15, v1
    v_lshlrev_b32 v13, 3, v13
    v_lshrrev_b32 v11, 4, v1
    v_lshlrev_b32 v10, 1, v13
    v_lshl_add_u32 v12, v11, 10, v10
    ds_read_b64_tr_b16 a[240:241], v7 offset:0
    ds_read_b64_tr_b16 a[242:243], v7 offset:256
    ds_read_b64_tr_b16 a[244:245], v7 offset:7168
    ds_read_b64_tr_b16 a[246:247], v7 offset:7424
    ds_read_b64_tr_b16 a[248:249], v7 offset:14336
    ds_read_b64_tr_b16 a[250:251], v7 offset:14592
    ds_read_b64_tr_b16 a[252:253], v7 offset:21504
    ds_read_b64_tr_b16 a[254:255], v7 offset:21760
    s_waitcnt lgkmcnt(12)
    v_add_f32 v200, v200, v80
    v_add_f32 v201, v201, v81
    v_add_f32 v202, v202, v82
    v_add_f32 v203, v203, v83
    s_waitcnt lgkmcnt(10)
    v_add_f32 v200, v200, v88
    v_add_f32 v201, v201, v89
    v_add_f32 v206, v206, v86
    v_add_f32 v202, v202, v90
    v_add_f32 v203, v203, v91
    v_add_f32 v204, v204, v84
    v_add_f32 v205, v205, v85
    v_add_f32 v206, v206, v94
    s_waitcnt lgkmcnt(8)
    v_add_f32 v200, v200, v96
    v_add_f32 v201, v201, v97
    v_add_f32 v202, v202, v98
    v_add_f32 v203, v203, v99
    v_cvt_pk_bf16_f32 v200, v200, v201
    v_add_f32 v204, v204, v92
    v_add_f32 v205, v205, v93
    v_add_f32 v206, v206, v102
    v_cvt_pk_bf16_f32 v201, v202, v203
    v_add_f32 v204, v204, v100
    v_add_f32_e64 v205, v205, v101
    v_cvt_pk_bf16_f32 v203, v206, v207
    v_cvt_pk_bf16_f32 v202, v204, v205
    v_bfi_b32 v203, v2, v203, v248
    s_waitcnt lgkmcnt(0)
    v_mfma_f32_32x32x16_bf16 v[40:55], a[240:243], a[0:3], 0
    buffer_store_dwordx4 v[200:203], v249, s[40:43], s4 offen sc1
    ds_read_b64_tr_b16 a[224:225], v7 offset:1024
    ds_read_b64_tr_b16 a[226:227], v7 offset:1280
    ds_read_b64_tr_b16 a[228:229], v7 offset:8192
    v_mfma_f32_32x32x16_bf16 v[40:55], a[244:247], a[8:11], v[40:55]
    ds_read_b64_tr_b16 a[230:231], v7 offset:8448
    ds_read_b64_tr_b16 a[232:233], v7 offset:15360
    ds_read_b64_tr_b16 a[234:235], v7 offset:15616
    ds_read_b64_tr_b16 a[236:237], v7 offset:22528
    ds_read_b64_tr_b16 a[238:239], v7 offset:22784
    v_mfma_f32_32x32x16_bf16 v[40:55], a[248:251], a[16:19], v[40:55]
    s_waitcnt vmcnt(5)
    s_barrier
    s_add_u32 s87, s7, 155648
    s_add_u32 m0, s80, 32768
    v_mfma_f32_32x32x16_bf16 v[40:55], a[252:255], a[24:27], v[40:55]
    buffer_load_dwordx4 v252, s[32:35], s57 offen offset:0  lds
    buffer_load_dwordx4 v3, s[32:35], s57 offen offset:1024  lds
    buffer_load_dwordx4 v4, s[32:35], s57 offen offset:2048  lds
    v_mfma_f32_32x32x16_bf16 v[56:71], a[240:243], a[4:7], 0
    buffer_load_dwordx4 v5, s[32:35], s57 offen offset:3072  lds
    s_add_u32 m0, s80, 49152
    s_add_u32 s57, s57, 57344
    ds_read_b64_tr_b16 a[240:241], v7 offset:2048
    ds_read_b64_tr_b16 a[242:243], v7 offset:2304
    s_waitcnt lgkmcnt(8)
    v_mfma_f32_32x32x16_bf16 v[40:55], a[224:227], a[32:35], v[40:55]
    buffer_load_dwordx4 v252, s[32:35], s57 offen offset:0  lds
    v_mov_b32 v143, 0
    v_mov_b32 v159, 0
    v_mov_b32 v175, 0
    v_mfma_f32_32x32x16_bf16 v[56:71], a[244:247], a[12:15], v[56:71]
    ds_read_b64_tr_b16 a[244:245], v7 offset:9216
    ds_read_b64_tr_b16 a[246:247], v7 offset:9472
    v_mov_b32 v191, 0
    v_mov_b32 v151, 0
    v_mov_b32 v167, 0
    v_mov_b32 v183, 0
    s_waitcnt lgkmcnt(4)
    v_mfma_f32_32x32x16_bf16 v[40:55], a[228:231], a[40:43], v[40:55]
    buffer_load_dwordx4 v3, s[32:35], s57 offen offset:1024  lds
    v_mov_b32 v199, 0
    v_lshl_add_u32 v17, v11, 3, v10
    v_add_u32_e64 v10, s87, v17
    v_mfma_f32_32x32x16_bf16 v[56:71], a[248:251], a[20:23], v[56:71]
    ds_read_b64_tr_b16 a[248:249], v7 offset:16384
    ds_read_b64_tr_b16 a[250:251], v7 offset:16640
    v_add_u32 v17, 159744, v17
    v_cndmask_b32_e64 v17, v10, v17, s[60:61]
    v_mov_b32 v10, v12
    v_and_b32 v11, 1, v1
    v_mfma_f32_32x32x16_bf16 v[40:55], a[232:235], a[48:51], v[40:55]
    v_lshlrev_b32 v11, 4, v11
    v_mov_b32 v12, 0x3f80
    v_lshlrev_b32 v12, v11, v12
    v_and_b32 v11, 15, v1
    v_cmp_eq_u32 vcc, 7, v11
    v_mfma_f32_32x32x16_bf16 v[56:71], a[252:255], a[28:31], v[56:71]
    ds_read_b64_tr_b16 a[252:253], v7 offset:23552
    ds_read_b64_tr_b16 a[254:255], v7 offset:23808
    v_lshrrev_b32_e64 v11, 1, v11
    v_cmp_eq_u32_e64 s[54:55], 0, v11
    v_cmp_eq_u32_e64 s[72:73], 1, v11
    v_cndmask_b32_e64 v12, v12, 0, vcc
    v_mfma_f32_32x32x16_bf16 v[40:55], a[236:239], a[56:59], v[40:55]
    v_cndmask_b32_e64 v28, 0, v12, s[54:55]
    v_cndmask_b32_e64 v29, 0, v12, s[72:73]
    v_cmp_eq_u32_e64 s[54:55], 2, v11
    v_cmp_eq_u32_e64 s[72:73], 3, v11
    s_add_u32 s87, s7, 155648
    v_mfma_f32_32x32x16_bf16 v[56:71], a[224:227], a[36:39], v[56:71]
    ds_read_b64_tr_b16 a[224:225], v7 offset:3072
    ds_read_b64_tr_b16 a[226:227], v7 offset:3328
    v_add_u32 v6, s87, v249
    v_cndmask_b32_e64 v30, 0, v12, s[54:55]
    v_cndmask_b32_e64 v31, 0, v12, s[72:73]
    v_xor_b32 v253, 1024, v6
    s_waitcnt lgkmcnt(4)
    v_mfma_f32_32x32x16_bf16 v[40:55], a[240:243], a[64:67], v[40:55]
    v_xor_b32 v16, 2048, v6
    v_mfma_f32_32x32x16_bf16 v[56:71], a[228:231], a[44:47], v[56:71]
    ds_read_b64_tr_b16 a[228:229], v7 offset:10240
    ds_read_b64_tr_b16 a[230:231], v7 offset:10496
    v_mfma_f32_32x32x16_bf16 v[40:55], a[244:247], a[72:75], v[40:55]
    buffer_load_dwordx4 v4, s[32:35], s57 offen offset:2048  lds
    v_mfma_f32_32x32x16_bf16 v[56:71], a[232:235], a[52:55], v[56:71]
    ds_read_b64_tr_b16 a[232:233], v7 offset:17408
    ds_read_b64_tr_b16 a[234:235], v7 offset:17664
    v_mfma_f32_32x32x16_bf16 v[40:55], a[248:251], a[80:83], v[40:55]
    buffer_load_dwordx4 v5, s[32:35], s57 offen offset:3072  lds
    v_mfma_f32_32x32x16_bf16 v[56:71], a[236:239], a[60:63], v[56:71]
    ds_read_b64_tr_b16 a[236:237], v7 offset:24576
    ds_read_b64_tr_b16 a[238:239], v7 offset:24832
    s_waitcnt lgkmcnt(8)
    v_mfma_f32_32x32x16_bf16 v[40:55], a[252:255], a[88:91], v[40:55]
    v_mfma_f32_32x32x16_bf16 v[56:71], a[240:243], a[68:71], v[56:71]
    ds_read_b64_tr_b16 a[240:241], v7 offset:4096
    ds_read_b64_tr_b16 a[242:243], v7 offset:4352
    s_waitcnt lgkmcnt(8)
    v_mfma_f32_32x32x16_bf16 v[40:55], a[224:227], a[96:99], v[40:55]
    v_mfma_f32_32x32x16_bf16 v[56:71], a[244:247], a[76:79], v[56:71]
    ds_read_b64_tr_b16 a[244:245], v7 offset:11264
    ds_read_b64_tr_b16 a[246:247], v7 offset:11520
    s_waitcnt lgkmcnt(8)
    v_mfma_f32_32x32x16_bf16 v[40:55], a[228:231], a[104:107], v[40:55]
    v_mfma_f32_32x32x16_bf16 v[56:71], a[248:251], a[84:87], v[56:71]
    ds_read_b64_tr_b16 a[248:249], v7 offset:18432
    ds_read_b64_tr_b16 a[250:251], v7 offset:18688
    s_waitcnt lgkmcnt(8)
    v_mfma_f32_32x32x16_bf16 v[40:55], a[232:235], a[112:115], v[40:55]
    v_mfma_f32_32x32x16_bf16 v[56:71], a[252:255], a[92:95], v[56:71]
    ds_read_b64_tr_b16 a[252:253], v7 offset:25600
    ds_read_b64_tr_b16 a[254:255], v7 offset:25856
    s_waitcnt lgkmcnt(8)
    v_mfma_f32_32x32x16_bf16 v[40:55], a[236:239], a[120:123], v[40:55]
    v_mfma_f32_32x32x16_bf16 v[56:71], a[224:227], a[100:103], v[56:71]
    ds_read_b64_tr_b16 a[224:225], v7 offset:5120
    ds_read_b64_tr_b16 a[226:227], v7 offset:5376
    s_waitcnt lgkmcnt(8)
    v_mfma_f32_32x32x16_bf16 v[40:55], a[240:243], a[128:131], v[40:55]
    v_mfma_f32_32x32x16_bf16 v[56:71], a[228:231], a[108:111], v[56:71]
    ds_read_b64_tr_b16 a[228:229], v7 offset:12288
    ds_read_b64_tr_b16 a[230:231], v7 offset:12544
    s_waitcnt lgkmcnt(8)
    v_mfma_f32_32x32x16_bf16 v[40:55], a[244:247], a[136:139], v[40:55]
    v_mfma_f32_32x32x16_bf16 v[56:71], a[232:235], a[116:119], v[56:71]
    ds_read_b64_tr_b16 a[232:233], v7 offset:19456
    ds_read_b64_tr_b16 a[234:235], v7 offset:19712
    s_waitcnt lgkmcnt(8)
    v_mfma_f32_32x32x16_bf16 v[40:55], a[248:251], a[144:147], v[40:55]
    v_mfma_f32_32x32x16_bf16 v[56:71], a[236:239], a[124:127], v[56:71]
    ds_read_b64_tr_b16 a[236:237], v7 offset:26624
    ds_read_b64_tr_b16 a[238:239], v7 offset:26880
    s_waitcnt lgkmcnt(8)
    v_mfma_f32_32x32x16_bf16 v[40:55], a[252:255], a[152:155], v[40:55]
    v_mfma_f32_32x32x16_bf16 v[56:71], a[240:243], a[132:135], v[56:71]
    ds_read_b64_tr_b16 a[240:241], v7 offset:6144
    ds_read_b64_tr_b16 a[242:243], v7 offset:6400
    s_waitcnt lgkmcnt(8)
    v_mfma_f32_32x32x16_bf16 v[40:55], a[224:227], a[160:163], v[40:55]
    v_mfma_f32_32x32x16_bf16 v[56:71], a[244:247], a[140:143], v[56:71]
    ds_read_b64_tr_b16 a[244:245], v7 offset:13312
    ds_read_b64_tr_b16 a[246:247], v7 offset:13568
    s_waitcnt lgkmcnt(8)
    v_mfma_f32_32x32x16_bf16 v[40:55], a[228:231], a[168:171], v[40:55]
    v_mfma_f32_32x32x16_bf16 v[56:71], a[248:251], a[148:151], v[56:71]
    ds_read_b64_tr_b16 a[248:249], v7 offset:20480
    ds_read_b64_tr_b16 a[250:251], v7 offset:20736
    s_waitcnt lgkmcnt(8)
    v_mfma_f32_32x32x16_bf16 v[40:55], a[232:235], a[176:179], v[40:55]
    v_mfma_f32_32x32x16_bf16 v[56:71], a[252:255], a[156:159], v[56:71]
    ds_read_b64_tr_b16 a[252:253], v7 offset:27648
    ds_read_b64_tr_b16 a[254:255], v7 offset:27904
    v_xor_b32 v7, 3072, v6
    s_waitcnt lgkmcnt(8)
    v_mfma_f32_32x32x16_bf16 v[40:55], a[236:239], a[184:187], v[40:55]
    s_waitcnt lgkmcnt(6)
    v_mfma_f32_32x32x16_bf16 v[40:55], a[240:243], a[192:195], v[40:55]
    s_waitcnt lgkmcnt(4)
    v_mfma_f32_32x32x16_bf16 v[40:55], a[244:247], a[200:203], v[40:55]
    s_waitcnt lgkmcnt(2)
    v_mfma_f32_32x32x16_bf16 v[40:55], a[248:251], a[208:211], v[40:55]
    s_waitcnt lgkmcnt(0)
    v_mfma_f32_32x32x16_bf16 v[40:55], a[252:255], a[216:219], v[40:55]
    v_mfma_f32_32x32x16_bf16 v[56:71], a[224:227], a[164:167], v[56:71]
    s_nop 10
    v_cvt_pk_bf16_f32 v40, v40, v41
    v_cvt_pk_bf16_f32 v41, v42, v43
    v_mfma_f32_32x32x16_bf16 v[56:71], a[228:231], a[172:175], v[56:71]
    v_cvt_pk_bf16_f32 v42, v44, v45
    v_cvt_pk_bf16_f32 v43, v46, v47
    v_cvt_pk_bf16_f32 v46, v52, v53
    v_cvt_pk_bf16_f32 v47, v54, v55
    v_cvt_pk_bf16_f32 v44, v48, v49
    v_cvt_pk_bf16_f32 v45, v50, v51
    v_mfma_f32_32x32x16_bf16 v[104:119], v[20:23], v[40:43], 0
    v_cndmask_b32_e64 v46, v46, 0, s[60:61]
    v_cndmask_b32_e64 v47, v47, 0, s[60:61]
    s_nop 1
    v_mfma_f32_32x32x16_bf16 v[104:119], v[24:27], v[44:47], v[104:119]
    v_mfma_f32_32x32x16_bf16 v[56:71], a[232:235], a[180:183], v[56:71]
    buffer_load_dwordx2 v[38:39], v13, s[40:43], s8 offen sc1
    buffer_load_dwordx4 v[200:203], v10, s[40:43], s5 offen offset:0 sc1
    v_mfma_f32_32x32x16_bf16 v[56:71], a[236:239], a[188:191], v[56:71]
    buffer_load_dwordx4 v[204:207], v10, s[40:43], s5 offen offset:256 sc1
    buffer_load_dwordx4 v[208:211], v10, s[40:43], s5 offen offset:512 sc1
    buffer_load_dwordx4 v[212:215], v10, s[40:43], s5 offen offset:768 sc1
    v_mfma_f32_32x32x16_bf16 v[56:71], a[240:243], a[196:199], v[56:71]
    s_nop 3
    v_max3_f32 v232, v104, v105, v106
    v_max3_f32 v233, v112, v113, v114
    v_max3_f32 v234, -v104, -v105, -v106
    v_max3_f32 v235, -v112, -v113, -v114
    v_max3_f32 v232, v232, v107, v108
    v_max3_f32 v233, v233, v115, v116
    v_mfma_f32_32x32x16_bf16 v[56:71], a[244:247], a[204:207], v[56:71]
    buffer_load_dwordx4 v[216:219], v10, s[40:43], s6 offen offset:0 sc1
    v_max3_f32 v234, v234, -v107, -v108
    v_max3_f32 v235, v235, -v115, -v116
    v_max3_f32 v232, v232, v109, v110
    v_max3_f32 v233, v233, v117, v118
    v_mfma_f32_32x32x16_bf16 v[56:71], a[248:251], a[212:215], v[56:71]
    v_max3_f32 v234, v234, -v109, -v110
    v_max3_f32 v235, v235, -v117, -v118
    v_max_f32 v232, v232, v233
    v_max_f32 v234, v234, v235
    v_mfma_f32_32x32x16_bf16 v[56:71], a[252:255], a[220:223], v[56:71]
    buffer_load_dwordx4 v[220:223], v10, s[40:43], s6 offen offset:256 sc1
    v_permlane32_swap_b32 v232, v234
    v_max_f32 v232, v232, v234
    v_mul_f32 v232, v36, v232
    v_mov_b32_e64 v234, v232
    s_nop 1
    v_permlane32_swap_b32 v232, v234
    v_pk_fma_f32 v[136:137], v[104:105], v[36:37], v[232:233] op_sel_hi:[1,0,0] neg_lo:[0,0,1] neg_hi:[0,0,1]
    s_nop 2
    v_cvt_pk_bf16_f32 v56, v56, v57
    v_cvt_pk_bf16_f32 v57, v58, v59
    v_cvt_pk_bf16_f32 v58, v60, v61
    buffer_load_dwordx4 v[224:227], v10, s[40:43], s6 offen offset:512 sc1
    v_cvt_pk_bf16_f32 v59, v62, v63
    v_cvt_pk_bf16_f32 v62, v68, v69
    v_cvt_pk_bf16_f32 v63, v70, v71
    v_mfma_f32_32x32x16_bf16 v[120:135], v[20:23], v[56:59], 0
    v_cvt_pk_bf16_f32 v60, v64, v65
    v_cvt_pk_bf16_f32 v61, v66, v67
    v_cndmask_b32_e64 v62, v62, 0, s[60:61]
    v_cndmask_b32_e64 v63, v63, 0, s[60:61]
    v_exp_f32 v136, v136
    s_nop 0
    v_mfma_f32_32x32x16_bf16 v[120:135], v[24:27], v[60:63], v[120:135]
    v_exp_f32 v137, v137
    buffer_load_dwordx4 v[228:231], v10, s[40:43], s6 offen offset:768 sc1
    v_fma_f32 v142, v110, v36, -v232
    v_fma_f32 v158, -v110, v36, -v234
    v_exp_f32_e64 v142, v142
    v_pk_fma_f32 v[138:139], v[106:107], v[36:37], v[232:233] op_sel_hi:[1,0,0] neg_lo:[0,0,1] neg_hi:[0,0,1]
    v_pk_fma_f32 v[152:153], v[104:105], v[36:37], v[234:235] op_sel_hi:[1,0,0] neg_lo:[1,0,1] neg_hi:[1,0,1]
    s_nop 4
    v_max3_f32 v240, v120, v121, v122
    v_max3_f32 v241, v128, v129, v130
    v_max3_f32 v242, -v120, -v121, -v122
    v_max3_f32 v243, -v128, -v129, -v130
    v_max3_f32 v240, v240, v123, v124
    v_max3_f32 v241, v241, v131, v132
    v_max3_f32 v242, v242, -v123, -v124
    v_max3_f32 v243, v243, -v131, -v132
    v_max3_f32 v240, v240, v125, v126
    v_max3_f32 v241, v241, v133, v134
    v_max3_f32 v242, v242, -v125, -v126
    v_max3_f32 v243, v243, -v133, -v134
    v_max_f32 v240, v240, v241
    v_max_f32 v242, v242, v243
    v_pk_fma_f32 v[154:155], v[106:107], v[36:37], v[234:235] op_sel_hi:[1,0,0] neg_lo:[1,0,1] neg_hi:[1,0,1]
    v_exp_f32 v138, v138
    v_permlane32_swap_b32 v240, v242
    v_max_f32 v240, v240, v242
    v_mul_f32 v240, v36, v240
    v_mov_b32 v242, v240
    v_exp_f32 v139, v139
    s_nop 0
    v_permlane32_swap_b32 v240, v242
    v_pk_fma_f32 v[168:169], v[120:121], v[36:37], v[240:241] op_sel_hi:[1,0,0] neg_lo:[0,0,1] neg_hi:[0,0,1]
    v_pk_fma_f32 v[170:171], v[122:123], v[36:37], v[240:241] op_sel_hi:[1,0,0] neg_lo:[0,0,1] neg_hi:[0,0,1]
    v_pk_fma_f32 v[184:185], v[120:121], v[36:37], v[242:243] op_sel_hi:[1,0,0] neg_lo:[1,0,1] neg_hi:[1,0,1]
    v_pk_fma_f32 v[186:187], v[122:123], v[36:37], v[242:243] op_sel_hi:[1,0,0] neg_lo:[1,0,1] neg_hi:[1,0,1]
    v_pk_fma_f32 v[140:141], v[108:109], v[36:37], v[232:233] op_sel_hi:[1,0,0] neg_lo:[0,0,1] neg_hi:[0,0,1]
    v_exp_f32 v152, v152
    v_exp_f32 v153, v153
    v_exp_f32 v154, v154
    v_exp_f32 v155, v155
    v_pk_fma_f32 v[156:157], v[108:109], v[36:37], v[234:235] op_sel_hi:[1,0,0] neg_lo:[1,0,1] neg_hi:[1,0,1]
    v_exp_f32 v168, v168
    v_exp_f32 v169, v169
    v_exp_f32 v170, v170
    v_exp_f32 v171, v171
    v_pk_fma_f32 v[172:173], v[124:125], v[36:37], v[240:241] op_sel_hi:[1,0,0] neg_lo:[0,0,1] neg_hi:[0,0,1]
    v_exp_f32 v184, v184
    v_exp_f32 v185, v185
    v_exp_f32 v186, v186
    v_exp_f32 v187, v187
    v_pk_fma_f32 v[188:189], v[124:125], v[36:37], v[242:243] op_sel_hi:[1,0,0] neg_lo:[1,0,1] neg_hi:[1,0,1]
    v_exp_f32 v140, v140
    v_exp_f32 v141, v141
    v_exp_f32 v156, v156
    v_exp_f32 v157, v157
    v_exp_f32 v172, v172
    v_exp_f32 v173, v173
    v_fma_f32 v174, v126, v36, -v240
    v_exp_f32 v188, v188
    v_exp_f32 v189, v189
    v_fma_f32 v190, -v126, v36, -v242
    v_pk_fma_f32 v[144:145], v[112:113], v[36:37], v[232:233] op_sel_hi:[1,0,0] neg_lo:[0,0,1] neg_hi:[0,0,1]
    v_exp_f32 v158, v158
    v_pk_fma_f32 v[160:161], v[112:113], v[36:37], v[234:235] op_sel_hi:[1,0,0] neg_lo:[1,0,1] neg_hi:[1,0,1]
    v_exp_f32 v174, v174
    v_pk_fma_f32 v[176:177], v[128:129], v[36:37], v[240:241] op_sel_hi:[1,0,0] neg_lo:[0,0,1] neg_hi:[0,0,1]
    v_exp_f32 v190, v190
    v_pk_fma_f32 v[192:193], v[128:129], v[36:37], v[242:243] op_sel_hi:[1,0,0] neg_lo:[1,0,1] neg_hi:[1,0,1]
    v_exp_f32 v144, v144
    v_exp_f32 v145, v145
    v_pk_fma_f32 v[146:147], v[114:115], v[36:37], v[232:233] op_sel_hi:[1,0,0] neg_lo:[0,0,1] neg_hi:[0,0,1]
    v_exp_f32 v160, v160
    v_exp_f32 v161, v161
    v_pk_fma_f32 v[162:163], v[114:115], v[36:37], v[234:235] op_sel_hi:[1,0,0] neg_lo:[1,0,1] neg_hi:[1,0,1]
    v_pk_add_f32 v[236:237], v[136:137], v[138:139]
    v_pk_add_f32 v[238:239], v[152:153], v[154:155]
    v_exp_f32 v176, v176
    v_exp_f32 v177, v177
    v_pk_fma_f32 v[178:179], v[130:131], v[36:37], v[240:241] op_sel_hi:[1,0,0] neg_lo:[0,0,1] neg_hi:[0,0,1]
    v_exp_f32 v192, v192
    v_exp_f32 v193, v193
    v_pk_fma_f32 v[194:195], v[130:131], v[36:37], v[242:243] op_sel_hi:[1,0,0] neg_lo:[1,0,1] neg_hi:[1,0,1]
    v_pk_add_f32 v[244:245], v[168:169], v[170:171]
    v_pk_add_f32 v[246:247], v[184:185], v[186:187]
    v_exp_f32 v146, v146
    v_exp_f32 v147, v147
    v_pk_fma_f32 v[148:149], v[116:117], v[36:37], v[232:233] op_sel_hi:[1,0,0] neg_lo:[0,0,1] neg_hi:[0,0,1]
    v_exp_f32 v162, v162
    v_exp_f32 v163, v163
    v_pk_fma_f32 v[164:165], v[116:117], v[36:37], v[234:235] op_sel_hi:[1,0,0] neg_lo:[1,0,1] neg_hi:[1,0,1]
    v_pk_add_f32 v[236:237], v[236:237], v[140:141]
    v_pk_add_f32 v[238:239], v[238:239], v[156:157]
    v_exp_f32 v178, v178
    v_exp_f32 v179, v179
    v_pk_fma_f32 v[180:181], v[132:133], v[36:37], v[240:241] op_sel_hi:[1,0,0] neg_lo:[0,0,1] neg_hi:[0,0,1]
    v_exp_f32 v194, v194
    v_exp_f32 v195, v195
    v_pk_fma_f32 v[196:197], v[132:133], v[36:37], v[242:243] op_sel_hi:[1,0,0] neg_lo:[1,0,1] neg_hi:[1,0,1]
    v_pk_add_f32 v[244:245], v[244:245], v[172:173]
    v_pk_add_f32 v[246:247], v[246:247], v[188:189]
    v_exp_f32 v148, v148
    v_exp_f32 v149, v149
    v_fma_f32 v150, v118, v36, -v232
    v_exp_f32 v164, v164
    v_exp_f32 v165, v165
    v_fma_f32 v166, -v118, v36, -v234
    v_pk_add_f32 v[236:237], v[236:237], v[142:143]
    v_pk_add_f32 v[238:239], v[238:239], v[158:159]
    v_exp_f32 v180, v180
    v_exp_f32 v181, v181
    v_fma_f32 v182, v134, v36, -v240
    v_exp_f32 v196, v196
    v_exp_f32 v197, v197
    v_fma_f32 v198, -v134, v36, -v242
    v_pk_add_f32 v[244:245], v[244:245], v[174:175]
    v_pk_add_f32 v[246:247], v[246:247], v[190:191]
    v_exp_f32 v150, v150
    v_exp_f32 v166, v166
    v_pk_add_f32 v[236:237], v[236:237], v[144:145]
    v_pk_add_f32 v[238:239], v[238:239], v[160:161]
    v_exp_f32 v182, v182
    v_exp_f32_e64 v198, v198
    v_pk_add_f32 v[244:245], v[244:245], v[176:177]
    v_pk_add_f32 v[246:247], v[246:247], v[192:193]
    v_pk_add_f32 v[236:237], v[236:237], v[146:147]
    v_pk_add_f32 v[238:239], v[238:239], v[162:163]
    v_pk_add_f32 v[244:245], v[244:245], v[178:179]
    v_pk_add_f32 v[246:247], v[246:247], v[194:195]
    v_pk_add_f32 v[236:237], v[236:237], v[148:149]
    v_pk_add_f32 v[238:239], v[238:239], v[164:165]
    v_pk_add_f32 v[244:245], v[244:245], v[180:181]
    v_pk_add_f32 v[246:247], v[246:247], v[196:197]
    v_pk_add_f32 v[236:237], v[236:237], v[150:151]
    v_pk_add_f32 v[238:239], v[238:239], v[166:167]
    v_pk_add_f32 v[244:245], v[244:245], v[182:183]
    v_pk_add_f32 v[246:247], v[246:247], v[198:199]
    v_add_f32 v236, v236, v237
    v_add_f32 v238, v238, v239
    v_add_f32 v244, v244, v245
    v_add_f32 v246, v246, v247
    v_permlane32_swap_b32 v236, v238
    s_nop 0
    v_permlane32_swap_b32 v244, v246
    v_add_f32 v236, v236, v238
    v_add_f32 v244, v244, v246
    v_mov_b32 v238, v236
    v_mov_b32 v246, v244
    v_cvt_pk_bf16_f32 v136, v136, v137
    v_permlane32_swap_b32 v236, v238
    v_permlane32_swap_b32 v244, v246
    v_rcp_f32 v238, v238
    v_rcp_f32 v246, v246
    v_mul_f32 v238, v236, v238
    v_mul_f32_e64 v246, v244, v246
    v_pk_mul_f32 v[152:153], v[152:153], v[238:239] op_sel_hi:[1,0]
    v_pk_mul_f32 v[184:185], v[184:185], v[246:247] op_sel_hi:[1,0]
    v_cvt_pk_bf16_f32 v152, v152, v153
    v_pk_mul_f32 v[154:155], v[154:155], v[238:239] op_sel_hi:[1,0]
    v_cvt_pk_bf16_f32 v168, v168, v169
    v_cvt_pk_bf16_f32 v184, v184, v185
    v_pk_mul_f32 v[186:187], v[186:187], v[246:247] op_sel_hi:[1,0]
    v_cvt_pk_bf16_f32 v137, v138, v139
    v_cvt_pk_bf16_f32 v153, v154, v155
    v_pk_mul_f32 v[156:157], v[156:157], v[238:239] op_sel_hi:[1,0]
    v_pk_mul_f32 v[158:159], v[158:159], v[238:239] op_sel_hi:[1,0]
    v_cvt_pk_bf16_f32 v169, v170, v171
    v_cvt_pk_bf16_f32 v185, v186, v187
    v_pk_mul_f32 v[188:189], v[188:189], v[246:247] op_sel_hi:[1,0]
    v_pk_mul_f32 v[190:191], v[190:191], v[246:247] op_sel_hi:[1,0]
    v_cvt_pk_bf16_f32 v138, v140, v141
    v_cvt_pk_bf16_f32 v139, v142, v143
    v_cvt_pk_bf16_f32 v154, v156, v157
    v_cvt_pk_bf16_f32 v155, v158, v159
    v_pk_mul_f32 v[160:161], v[160:161], v[238:239] op_sel_hi:[1,0]
    v_pk_mul_f32 v[162:163], v[162:163], v[238:239] op_sel_hi:[1,0]
    v_pk_mul_f32 v[164:165], v[164:165], v[238:239] op_sel_hi:[1,0]
    v_pk_mul_f32 v[166:167], v[166:167], v[238:239] op_sel_hi:[1,0]
    v_cvt_pk_bf16_f32 v170, v172, v173
    v_cvt_pk_bf16_f32 v171, v174, v175
    v_cvt_pk_bf16_f32 v186, v188, v189
    v_cvt_pk_bf16_f32 v187, v190, v191
    v_pk_mul_f32 v[192:193], v[192:193], v[246:247] op_sel_hi:[1,0]
    v_pk_mul_f32 v[194:195], v[194:195], v[246:247] op_sel_hi:[1,0]
    v_pk_mul_f32 v[196:197], v[196:197], v[246:247] op_sel_hi:[1,0]
    v_pk_mul_f32 v[198:199], v[198:199], v[246:247] op_sel_hi:[1,0]
    v_mul_f32 v55, 0x358637bd, v236
    v_cvt_pk_bf16_f32 v140, v144, v145
    v_cvt_pk_bf16_f32 v141, v146, v147
    v_cvt_pk_bf16_f32 v142, v148, v149
    v_cvt_pk_bf16_f32 v143, v150, v151
    v_cvt_pk_bf16_f32 v156, v160, v161
    v_cvt_pk_bf16_f32 v157, v162, v163
    v_cvt_pk_bf16_f32 v158, v164, v165
    v_cvt_pk_bf16_f32 v159, v166, v167
    v_mul_f32 v71, 0x358637bd, v244
    v_cvt_pk_bf16_f32 v172, v176, v177
    v_cvt_pk_bf16_f32 v173, v178, v179
    v_cvt_pk_bf16_f32 v174, v180, v181
    v_cvt_pk_bf16_f32 v175, v182, v183
    v_cvt_pk_bf16_f32 v188, v192, v193
    v_cvt_pk_bf16_f32 v189, v194, v195
    v_cvt_pk_bf16_f32 v190, v196, v197
    v_cvt_pk_bf16_f32 v191, v198, v199
    s_waitcnt vmcnt(0)
L_part_chkB:
    v_mfma_f32_16x16x32_bf16 v[72:75], v[28:31], v[200:203], 0
    v_max3_u32 v232, v203, v207, v211
    v_min3_u32 v244, v203, v207, v211
    v_mfma_f32_16x16x32_bf16 v[76:79], v[28:31], v[204:207], 0
    v_max3_u32 v232, v232, v215, v219
    v_min3_u32 v244, v244, v215, v219
    v_mfma_f32_16x16x32_bf16 v[80:83], v[28:31], v[208:211], 0
    v_max3_u32 v232, v232, v223, v227
    v_min3_u32 v244, v244, v223, v227
    v_mfma_f32_16x16x32_bf16 v[84:87], v[28:31], v[212:215], 0
    v_max_u32 v232, v232, v231
    v_min_u32 v244, v244, v231
    v_mfma_f32_16x16x32_bf16 v[72:75], v[28:31], v[216:219], v[72:75]
    v_xor_b32 v232, v232, v248
    v_xor_b32 v244, v244, v248
    v_mfma_f32_16x16x32_bf16 v[76:79], v[28:31], v[220:223], v[76:79]
    v_xor_b32 v233, s99, v39
    v_or_b32 v232, v232, v244
    v_mfma_f32_16x16x32_bf16 v[80:83], v[28:31], v[224:227], v[80:83]
    v_cmp_ne_u32_e64 s[72:73], 0, v233
    v_lshrrev_b32 v232, 16, v232
    v_mfma_f32_16x16x32_bf16 v[84:87], v[28:31], v[228:231], v[84:87]
    v_xor_b32 v244, s58, v38
    v_lshrrev_b32 v233, 4, v233
    v_or3_b32 v232, v232, v244, v233
    v_cmp_ne_u32 vcc, 0, v232
    s_nop 1
    s_cbranch_vccnz L_part_retryB
    v_and_b32 v8, 0x300, v249
    v_lshrrev_b32 v8, 2, v8
    global_load_dwordx4 v[20:23], v8, s[24:25] offset:0
    global_load_dwordx4 v[24:27], v8, s[24:25] offset:16
    global_load_dwordx4 v[32:35], v8, s[24:25] offset:32
    global_load_dwordx2 v[254:255], v8, s[24:25] offset:48
    v_cvt_pk_bf16_f32 v72, v72, v73
    v_cvt_pk_bf16_f32 v73, v74, v75
    v_cvt_pk_bf16_f32 v76, v76, v77
    v_cvt_pk_bf16_f32 v77, v78, v79
    v_cvt_pk_bf16_f32 v80, v80, v81
    v_cvt_pk_bf16_f32 v81, v82, v83
    v_cvt_pk_bf16_f32 v84, v84, v85
    v_cvt_pk_bf16_f32 v85, v86, v87
    ds_write_b64 v17, v[72:73] offset:0
    ds_write_b64 v17, v[76:77] offset:256
    ds_write_b64 v17, v[80:81] offset:512
    ds_write_b64 v17, v[84:85] offset:768
    s_waitcnt lgkmcnt(0)
    s_barrier
    ds_read_b128 v[88:91], v6
    ds_read_b128 v[92:95], v253
    ds_read_b128 v[96:99], v16
    s_add_u32 m0, s80, 65536
    s_add_u32 s57, s57, 57344
    ds_read_b128 v[100:103], v7
    buffer_load_dwordx4 v252, s[32:35], s57 offen offset:0  lds
    buffer_load_dwordx4 v3, s[32:35], s57 offen offset:1024  lds
    buffer_load_dwordx4 v4, s[32:35], s57 offen offset:2048  lds
    buffer_load_dwordx4 v5, s[32:35], s57 offen offset:3072  lds
    s_add_u32 m0, s80, 81920
    s_add_u32 s57, s57, 57344
    v_xor_b32 v251, 32, v250
    v_mov_b32 v38, s58
    v_mov_b32_e64 v39, s59
    buffer_load_dwordx4 v252, s[32:35], s57 offen offset:0  lds
    v_add_u32 v14, 0x10000, v250
    v_add_u32 v15, 0x10000, v251
    ds_read_b64_tr_b16 a[0:1], v250 offset:0
    ds_read_b64_tr_b16 a[2:3], v250 offset:1024
    ds_read_b64_tr_b16 a[4:5], v251 offset:0
    ds_read_b64_tr_b16 a[6:7], v251 offset:1024
    ds_read_b64_tr_b16 a[8:9], v250 offset:8192
    s_waitcnt lgkmcnt(8)
    v_mfma_f32_32x32x16_bf16 v[104:119], v[88:91], v[136:139], 0
    ds_read_b64_tr_b16 a[10:11], v250 offset:9216
    ds_read_b64_tr_b16 a[12:13], v251 offset:8192
    buffer_load_dwordx4 v3, s[32:35], s57 offen offset:1024  lds
    ds_read_b64_tr_b16 a[14:15], v251 offset:9216
    v_mfma_f32_32x32x16_bf16 v[120:135], v[88:91], v[168:171], 0
    ds_read_b64_tr_b16 a[16:17], v250 offset:16384
    ds_read_b64_tr_b16 a[18:19], v250 offset:17408
    ds_read_b64_tr_b16 a[20:21], v251 offset:16384
    ds_read_b64_tr_b16 a[22:23], v251 offset:17408
    ds_read_b64_tr_b16 a[24:25], v250 offset:24576
    ds_read_b64_tr_b16 a[26:27], v250 offset:25600
    s_waitcnt lgkmcnt(14)
    v_mfma_f32_32x32x16_bf16 v[104:119], v[92:95], v[140:143], v[104:119]
    ds_read_b64_tr_b16 a[28:29], v251 offset:24576
    ds_read_b64_tr_b16 a[30:31], v251 offset:25600
    buffer_load_dwordx4 v4, s[32:35], s57 offen offset:2048  lds
    v_mfma_f32_32x32x16_bf16 v[120:135], v[92:95], v[172:175], v[120:135]
    v_mfma_f32_32x32x16_bf16 v[104:119], v[96:99], v[152:155], v[104:119]
    buffer_load_dwordx4 v5, s[32:35], s57 offen offset:3072  lds
    v_mfma_f32_32x32x16_bf16 v[120:135], v[96:99], v[184:187], v[120:135]
    s_add_u32 m0, s80, 98304
    s_add_u32 s57, s57, 57344
    s_lshl_b32 s56, s50, 3
    s_add_u32 s88, s53, s56
    s_xor_b32 s96, s90, 32768
    s_add_u32 s86, s90, 16384
    v_mfma_f32_32x32x16_bf16 v[104:119], v[100:103], v[156:159], v[104:119]
    s_add_u32 s87, s96, 16384
    buffer_load_dwordx4 v252, s[32:35], s57 offen offset:0  lds
    v_mfma_f32_32x32x16_bf16 v[120:135], v[100:103], v[188:191], v[120:135]
    s_nop 8
    v_mov_b32 v236, v116
    s_nop 1
    v_permlane32_swap_b32 v116, v236
    v_add_f32 v236, v55, v236
    v_rcp_f32 v236, v236
    s_nop 0
    v_mul_f32 v104, v104, v236
    v_mov_b32 v240, v132
    buffer_load_dwordx4 v3, s[32:35], s57 offen offset:1024  lds
    s_nop 0
    v_permlane32_swap_b32 v132, v240
    v_add_f32 v240, v71, v240
    v_rcp_f32 v240, v240
    v_mul_f32 v105, v105, v236
    v_pk_mul_f32 v[120:121], v[120:121], v[240:241] op_sel_hi:[1,0]
    v_cvt_pk_bf16_f32 v104, v104, v105
    v_mul_f32 v106, v106, v236
    v_mul_f32 v107, v107, v236
    v_cvt_pk_bf16_f32 v120, v120, v121
    v_pk_mul_f32 v[122:123], v[122:123], v[240:241] op_sel_hi:[1,0]
    v_cvt_pk_bf16_f32 v105, v106, v107
    v_mul_f32 v108, v108, v236
    buffer_load_dwordx4 v4, s[32:35], s57 offen offset:2048  lds
    v_mul_f32 v109, v109, v236
    v_mul_f32 v110, v110, v236
    v_mul_f32 v111, v111, v236
    v_cvt_pk_bf16_f32 v121, v122, v123
    v_pk_mul_f32 v[124:125], v[124:125], v[240:241] op_sel_hi:[1,0]
    v_pk_mul_f32 v[126:127], v[126:127], v[240:241] op_sel_hi:[1,0]
    v_cvt_pk_bf16_f32 v106, v108, v109
    v_cvt_pk_bf16_f32 v107, v110, v111
    v_mul_f32 v112, v112, v236
    v_mul_f32 v113, v113, v236
    v_mul_f32 v114, v114, v236
    v_mul_f32 v115, v115, v236
    v_mul_f32 v116, v116, v236
    v_mul_f32 v117, v117, v236
    buffer_load_dwordx4 v5, s[32:35], s57 offen offset:3072  lds
    v_mul_f32 v118, v118, v236
    v_mul_f32 v119, v119, v236
    v_cvt_pk_bf16_f32 v122, v124, v125
    v_cvt_pk_bf16_f32 v123, v126, v127
    v_pk_mul_f32 v[128:129], v[128:129], v[240:241] op_sel_hi:[1,0]
    v_pk_mul_f32 v[130:131], v[130:131], v[240:241] op_sel_hi:[1,0]
    v_pk_mul_f32 v[132:133], v[132:133], v[240:241] op_sel_hi:[1,0]
    v_pk_mul_f32 v[134:135], v[134:135], v[240:241] op_sel_hi:[1,0]
    v_cvt_pk_bf16_f32 v108, v112, v113
    v_cvt_pk_bf16_f32 v109, v114, v115
    v_cvt_pk_bf16_f32 v110, v116, v117
    v_cvt_pk_bf16_f32 v111, v118, v119
    v_cvt_pk_bf16_f32 v124, v128, v129
    v_cvt_pk_bf16_f32 v125, v130, v131
    v_cvt_pk_bf16_f32 v126, v132, v133
    v_cvt_pk_bf16_f32 v127, v134, v135
    s_cmp_lg_u64 s[72:73], 0
    s_cbranch_scc1 L_far
L_pub:
    s_add_u32 m0, s80, 114688
    s_add_u32 s57, s57, 57344
    buffer_store_dwordx4 v[104:107], v249, s[40:43], s90 offen
    s_lshl_b32 s56, s49, 2
    s_add_u32 s56, s56, s84
    s_mul_i32 s89, s56, 114688
    s_mul_i32 s56, s48, 896
    s_add_u32 s89, s89, s56
    s_lshl_b32 s56, s83, 2
    s_add_u32 s56, s56, s51
    s_cmp_ge_u32 s56, 14
    v_and_b32 v242, 15, v1
    v_lshlrev_b32 v235, 4, v242
    v_bfe_u32 v243, v1, 4, 1
    buffer_store_dwordx4 v[108:111], v249, s[40:43], s86 offen
    s_cselect_b32 s86, 0x40000000, 0
    s_lshl_b32 s56, s56, 6
    s_add_u32 s64, s89, s56
    s_add_u32 s65, s64, 28672
    s_add_u32 s66, s64, 57344
    s_add_u32 s67, s64, 86016
    v_lshrrev_b32 v244, 5, v1
    s_waitcnt vmcnt(17)
    v_add_u32 v20, v20, v235
    v_add_u32 v21, v21, v235
    v_add_u32 v22, v22, v235
    v_add_u32 v23, v23, v235
    s_waitcnt vmcnt(16)
    v_add_u32 v24, v24, v235
    v_add_u32 v25, v25, v235
    buffer_store_dwordx4 v[120:123], v249, s[40:43], s96 offen
    v_add_u32 v26, v26, v235
    v_add_u32 v27, v27, v235
    s_waitcnt vmcnt(16)
    v_add_u32 v32, v32, v235
    v_add_u32 v33, v33, v235
    v_add_u32 v34, v34, v235
    v_add_u32 v35, v35, v235
    s_waitcnt vmcnt(15)
    v_add_u32 v254, v254, v235
    v_add_u32_e64 v255, v255, v235
    buffer_store_dwordx4 v[124:127], v249, s[40:43], s87 offen
    s_lshl_b32 s87, s51, 12
    s_add_u32 s87, s87, 65536
    v_lshl_add_u32 v242, v242, 6, s87
    v_lshl_add_u32 v242, v243, 3, v242
    v_bfe_u32 v243, v1, 1, 2
    v_xor_b32 v243, v243, v244
    v_lshl_add_u32 v236, v243, 4, v242
    v_bfe_u32 v243, v1, 3, 2
    v_xor_b32 v243, v243, v1
    v_lshrrev_b32 v242, 2, v1
    v_and_b32 v243, 3, v243
    v_lshl_add_u32 v244, v242, 6, s87
    v_lshl_add_u32 v240, v243, 4, v244
    s_and_b32 s56, s85, 127
    v_mul_u32_u24 v242, 1792, v242
    v_and_b32 v243, 3, v1
    buffer_load_dwordx4 v252, s[32:35], s57 offen offset:0  lds
    s_or_b32 s56, s56, s51
    v_lshl_add_u32 v242, v243, 4, v242
    s_cmp_eq_u32 s56, 0
    v_add_u32 v241, s86, v242
    s_cselect_b32 s56, 0, 0x20000000
    s_lshl_b32 s86, s48, 7
    s_or_b32 s56, s56, s86
    v_add_u32 v234, s56, v19
    s_lshl2_add_u32 s56, s52, s84
    s_lshl2_add_u32 s56, s56, s51
    s_lshl_b32 s56, s56, 14
    s_add_u32 s89, s56, 2097152
    v_and_b32 v242, 15, v1
    s_lshl_b32 s91, s51, 14
    buffer_load_dwordx4 v3, s[32:35], s57 offen offset:1024  lds
    v_xor_b32 v237, 32, v236
    v_cmp_eq_u32_e64 s[74:75], s50, v242
    buffer_load_dwordx4 v4, s[32:35], s57 offen offset:2048  lds
    buffer_load_dwordx4 v5, s[32:35], s57 offen offset:3072  lds
    s_mov_b32 m0, s91
    s_waitcnt vmcnt(4)
    buffer_store_dwordx2 v[38:39], v19, s[40:43], s88 offen
L_join:
    buffer_load_dwordx2 v[232:233], v13, s[40:43], s97 offen sc1
    s_waitcnt lgkmcnt(0)
    s_barrier
    ds_read_b64_tr_b16 a[32:33], v250 offset:32768
    ds_read_b64_tr_b16 a[34:35], v250 offset:33792
    ds_read_b64_tr_b16 a[36:37], v251 offset:32768
    ds_read_b64_tr_b16 a[38:39], v251 offset:33792
    ds_read_b64_tr_b16 a[40:41], v250 offset:40960
    ds_read_b64_tr_b16 a[42:43], v250 offset:41984
    ds_read_b64_tr_b16 a[44:45], v251 offset:40960
    ds_read_b64_tr_b16 a[46:47], v251 offset:41984
    ds_read_b64_tr_b16 a[48:49], v250 offset:49152
    ds_read_b64_tr_b16 a[50:51], v250 offset:50176
    ds_read_b64_tr_b16 a[52:53], v251 offset:49152
    ds_read_b64_tr_b16 a[54:55], v251 offset:50176
    ds_read_b64_tr_b16 a[56:57], v250 offset:57344
    ds_read_b64_tr_b16 a[58:59], v250 offset:58368
    ds_read_b64_tr_b16 a[60:61], v251 offset:57344
    ds_read_b64_tr_b16 a[62:63], v251 offset:58368
    ds_read_b64_tr_b16 a[64:65], v14 offset:0
    ds_read_b64_tr_b16 a[66:67], v14 offset:1024
    ds_read_b64_tr_b16 a[68:69], v15 offset:0
    ds_read_b64_tr_b16 a[70:71], v15 offset:1024
    ds_read_b64_tr_b16 a[72:73], v14 offset:8192
    ds_read_b64_tr_b16 a[74:75], v14 offset:9216
    ds_read_b64_tr_b16 a[76:77], v15 offset:8192
    ds_read_b64_tr_b16 a[78:79], v15 offset:9216
L_poll:
    s_waitcnt vmcnt(0)
    v_xor_b32 v232, s58, v232
    v_xor_b32 v233, s59, v233
    v_or_b32_e64 v232, v232, v233
    v_cmp_ne_u32 vcc, 0, v232
    s_nop 1
    s_andn2_b64 vcc, vcc, s[74:75]
    s_cbranch_vccnz L_repoll
L_seen:
    buffer_load_dwordx4 v249, s[40:43], s89 offen offset:0 sc1 lds
    buffer_load_dwordx4 v249, s[40:43], s89 offen offset:1024 sc1 lds
    buffer_load_dwordx4 v249, s[40:43], s89 offen offset:2048 sc1 lds
    buffer_load_dwordx4 v249, s[40:43], s89 offen offset:3072 sc1 lds
    s_add_u32 m0, s91, 4096
    s_add_u32 s89, s89, 4096
    buffer_load_dwordx4 v249, s[40:43], s89 offen offset:0 sc1 lds
    buffer_load_dwordx4 v249, s[40:43], s89 offen offset:1024 sc1 lds
    buffer_load_dwordx4 v249, s[40:43], s89 offen offset:2048 sc1 lds
    buffer_load_dwordx4 v249, s[40:43], s89 offen offset:3072 sc1 lds
    s_waitcnt vmcnt(4)
    s_barrier
    ds_read_b64 v[136:137], v20 offset:0
    ds_read_b64 v[138:139], v21 offset:0
    ds_read_b64 v[140:141], v20 offset:256
    ds_read_b64 v[142:143], v21 offset:256
    ds_read_b64 v[144:145], v20 offset:32768
    ds_read_b64 v[146:147], v21 offset:32768
    ds_read_b64 v[148:149], v20 offset:33024
    ds_read_b64 v[150:151], v21 offset:33024
    s_waitcnt lgkmcnt(6)
    v_mfma_f32_16x16x32_bf16 v[40:43], a[0:3], v[136:139], 0
    ds_read_b64 v[152:153], v22 offset:0
    ds_read_b64 v[154:155], v23 offset:0
    v_mfma_f32_16x16x32_bf16 v[44:47], a[4:7], v[136:139], 0
    ds_read_b64 v[156:157], v22 offset:256
    ds_read_b64 v[158:159], v23 offset:256
    s_waitcnt lgkmcnt(8)
    v_mfma_f32_16x16x32_bf16 v[48:51], a[0:3], v[140:143], 0
    ds_read_b64 v[160:161], v22 offset:32768
    ds_read_b64 v[162:163], v23 offset:32768
    v_mfma_f32_16x16x32_bf16 v[52:55], a[4:7], v[140:143], 0
    ds_read_b64 v[164:165], v22 offset:33024
    ds_read_b64 v[166:167], v23 offset:33024
    s_waitcnt lgkmcnt(10)
    v_mfma_f32_16x16x32_bf16 v[56:59], a[0:3], v[144:147], 0
    ds_read_b64 v[168:169], v24 offset:0
    ds_read_b64 v[170:171], v25 offset:0
    v_mfma_f32_16x16x32_bf16 v[60:63], a[4:7], v[144:147], 0
    ds_read_b64 v[172:173], v24 offset:256
    ds_read_b64 v[174:175], v25 offset:256
    s_waitcnt lgkmcnt(12)
    v_mfma_f32_16x16x32_bf16 v[64:67], a[0:3], v[148:151], 0
    ds_read_b64 v[176:177], v24 offset:32768
    ds_read_b64 v[178:179], v25 offset:32768
    v_mfma_f32_16x16x32_bf16 v[68:71], a[4:7], v[148:151], 0
    ds_read_b64 v[180:181], v24 offset:33024
    ds_read_b64 v[182:183], v25 offset:33024
    s_waitcnt vmcnt(2)
    s_barrier
    s_waitcnt lgkmcnt(13)
    v_mfma_f32_16x16x32_bf16 v[40:43], a[8:11], v[152:155], v[40:43]
    s_add_u32 m0, s91, 8192
    s_add_u32 s89, s89, 4096
    buffer_load_dwordx4 v249, s[40:43], s89 offen offset:0 sc1 lds
    ds_read_b64 v[136:137], v26 offset:0
    v_mfma_f32_16x16x32_bf16 v[44:47], a[12:15], v[152:155], v[44:47]
    ds_read_b64 v[138:139], v27 offset:0
    s_waitcnt lgkmcnt(10)
    v_mfma_f32_16x16x32_bf16 v[48:51], a[8:11], v[156:159], v[48:51]
    buffer_load_dwordx4 v249, s[40:43], s89 offen offset:1024 sc1 lds
    ds_read_b64 v[140:141], v26 offset:256
    v_mfma_f32_16x16x32_bf16 v[52:55], a[12:15], v[156:159], v[52:55]
    ds_read_b64 v[142:143], v27 offset:256
    v_mfma_f32_16x16x32_bf16 v[56:59], a[8:11], v[160:163], v[56:59]
    buffer_load_dwordx4 v249, s[40:43], s89 offen offset:2048 sc1 lds
    ds_read_b64 v[144:145], v26 offset:32768
    v_mfma_f32_16x16x32_bf16 v[60:63], a[12:15], v[160:163], v[60:63]
    ds_read_b64 v[146:147], v27 offset:32768
    v_mfma_f32_16x16x32_bf16 v[64:67], a[8:11], v[164:167], v[64:67]
    buffer_load_dwordx4 v249, s[40:43], s89 offen offset:3072 sc1 lds
    ds_read_b64 v[148:149], v26 offset:33024
    v_mfma_f32_16x16x32_bf16 v[68:71], a[12:15], v[164:167], v[68:71]
    ds_read_b64 v[150:151], v27 offset:33024
    s_waitcnt lgkmcnt(8)
    v_mfma_f32_16x16x32_bf16 v[40:43], a[16:19], v[168:171], v[40:43]
    s_add_u32 m0, s91, 12288
    s_add_u32 s89, s89, 4096
    buffer_load_dwordx4 v249, s[40:43], s89 offen offset:0 sc1 lds
    ds_read_b64 v[152:153], v32 offset:0
    v_mfma_f32_16x16x32_bf16 v[44:47], a[20:23], v[168:171], v[44:47]
    ds_read_b64 v[154:155], v33 offset:0
    v_mfma_f32_16x16x32_bf16 v[48:51], a[16:19], v[172:175], v[48:51]
    buffer_load_dwordx4 v249, s[40:43], s89 offen offset:1024 sc1 lds
    ds_read_b64 v[156:157], v32 offset:256
    v_mfma_f32_16x16x32_bf16 v[52:55], a[20:23], v[172:175], v[52:55]
    ds_read_b64 v[158:159], v33 offset:256
    v_mfma_f32_16x16x32_bf16 v[56:59], a[16:19], v[176:179], v[56:59]
    buffer_load_dwordx4 v249, s[40:43], s89 offen offset:2048 sc1 lds
    ds_read_b64 v[160:161], v32 offset:32768
    v_mfma_f32_16x16x32_bf16 v[60:63], a[20:23], v[176:179], v[60:63]
    ds_read_b64 v[162:163], v33 offset:32768
    v_mfma_f32_16x16x32_bf16 v[64:67], a[16:19], v[180:183], v[64:67]
    buffer_load_dwordx4 v249, s[40:43], s89 offen offset:3072 sc1 lds
    ds_read_b64 v[164:165], v32 offset:33024
    v_mfma_f32_16x16x32_bf16 v[68:71], a[20:23], v[180:183], v[68:71]
    ds_read_b64 v[166:167], v33 offset:33024
    s_waitcnt vmcnt(8)
    s_barrier
    s_waitcnt lgkmcnt(8)
    v_mfma_f32_16x16x32_bf16 v[40:43], a[24:27], v[136:139], v[40:43]
    s_add_u32 m0, s80, 131072
    s_add_u32 s57, s57, 57344
    buffer_load_dwordx4 v252, s[32:35], s57 offen offset:0  lds
    ds_read_b64 v[168:169], v34 offset:0
    ds_read_b64 v[170:171], v35 offset:0
    v_mfma_f32_16x16x32_bf16 v[44:47], a[28:31], v[136:139], v[44:47]
    ds_read_b64_tr_b16 a[80:81], v14 offset:16384
    ds_read_b64 v[172:173], v34 offset:256
    v_mfma_f32_16x16x32_bf16 v[48:51], a[24:27], v[140:143], v[48:51]
    buffer_load_dwordx4 v3, s[32:35], s57 offen offset:1024  lds
    ds_read_b64 v[174:175], v35 offset:256
    ds_read_b64_tr_b16 a[82:83], v14 offset:17408
    v_mfma_f32_16x16x32_bf16 v[52:55], a[28:31], v[140:143], v[52:55]
    ds_read_b64 v[176:177], v34 offset:32768
    ds_read_b64 v[178:179], v35 offset:32768
    v_mfma_f32_16x16x32_bf16 v[56:59], a[24:27], v[144:147], v[56:59]
    buffer_load_dwordx4 v4, s[32:35], s57 offen offset:2048  lds
    ds_read_b64_tr_b16 a[84:85], v15 offset:16384
    ds_read_b64 v[180:181], v34 offset:33024
    v_mfma_f32_16x16x32_bf16 v[60:63], a[28:31], v[144:147], v[60:63]
    ds_read_b64 v[182:183], v35 offset:33024
    ds_read_b64_tr_b16 a[86:87], v15 offset:17408
    v_mfma_f32_16x16x32_bf16 v[64:67], a[24:27], v[148:151], v[64:67]
    buffer_load_dwordx4 v5, s[32:35], s57 offen offset:3072  lds
    v_mfma_f32_16x16x32_bf16 v[68:71], a[28:31], v[148:151], v[68:71]
    s_waitcnt lgkmcnt(12)
    v_mfma_f32_16x16x32_bf16 v[40:43], a[32:35], v[152:155], v[40:43]
    buffer_store_dwordx2 v[38:39], v234, s[40:43], 0 offen sc1
    ds_read_b64 v[136:137], v254 offset:0
    ds_read_b64 v[138:139], v255 offset:0
    v_mfma_f32_16x16x32_bf16 v[44:47], a[36:39], v[152:155], v[44:47]
    ds_read_b64_tr_b16 a[88:89], v14 offset:24576
    ds_read_b64 v[140:141], v254 offset:256
    v_mfma_f32_16x16x32_bf16 v[48:51], a[32:35], v[156:159], v[48:51]
    ds_read_b64 v[142:143], v255 offset:256
    ds_read_b64_tr_b16 a[90:91], v14 offset:25600
    v_mfma_f32_16x16x32_bf16 v[52:55], a[36:39], v[156:159], v[52:55]
    ds_read_b64 v[144:145], v254 offset:32768
    ds_read_b64 v[146:147], v255 offset:32768
    v_mfma_f32_16x16x32_bf16 v[56:59], a[32:35], v[160:163], v[56:59]
    ds_read_b64_tr_b16 a[92:93], v15 offset:24576
    ds_read_b64 v[148:149], v254 offset:33024
    v_mfma_f32_16x16x32_bf16 v[60:63], a[36:39], v[160:163], v[60:63]
    ds_read_b64 v[150:151], v255 offset:33024
    ds_read_b64_tr_b16 a[94:95], v15 offset:25600
    v_mfma_f32_16x16x32_bf16 v[64:67], a[32:35], v[164:167], v[64:67]
    v_mfma_f32_16x16x32_bf16 v[68:71], a[36:39], v[164:167], v[68:71]
    s_waitcnt vmcnt(9)
    s_barrier
    s_waitcnt lgkmcnt(12)
    v_mfma_f32_16x16x32_bf16 v[40:43], a[40:43], v[168:171], v[40:43]
    ds_read_b64 v[152:153], v20 offset:8192
    v_mfma_f32_16x16x32_bf16 v[44:47], a[44:47], v[168:171], v[44:47]
    ds_read_b64 v[154:155], v21 offset:8192
    v_mfma_f32_16x16x32_bf16 v[48:51], a[40:43], v[172:175], v[48:51]
    ds_read_b64 v[156:157], v20 offset:8448
    v_mfma_f32_16x16x32_bf16 v[52:55], a[44:47], v[172:175], v[52:55]
    ds_read_b64 v[158:159], v21 offset:8448
    v_mfma_f32_16x16x32_bf16 v[56:59], a[40:43], v[176:179], v[56:59]
    ds_read_b64 v[160:161], v20 offset:40960
    v_mfma_f32_16x16x32_bf16 v[60:63], a[44:47], v[176:179], v[60:63]
    ds_read_b64 v[162:163], v21 offset:40960
    v_mfma_f32_16x16x32_bf16 v[64:67], a[40:43], v[180:183], v[64:67]
    ds_read_b64 v[164:165], v20 offset:41216
    v_mfma_f32_16x16x32_bf16 v[68:71], a[44:47], v[180:183], v[68:71]
    ds_read_b64 v[166:167], v21 offset:41216
    s_waitcnt lgkmcnt(10)
    v_mfma_f32_16x16x32_bf16 v[40:43], a[48:51], v[136:139], v[40:43]
    ds_read_b64 v[168:169], v22 offset:8192
    v_mfma_f32_16x16x32_bf16 v[44:47], a[52:55], v[136:139], v[44:47]
    ds_read_b64 v[170:171], v23 offset:8192
    v_mfma_f32_16x16x32_bf16 v[48:51], a[48:51], v[140:143], v[48:51]
    ds_read_b64 v[172:173], v22 offset:8448
    v_mfma_f32_16x16x32_bf16 v[52:55], a[52:55], v[140:143], v[52:55]
    ds_read_b64 v[174:175], v23 offset:8448
    v_mfma_f32_16x16x32_bf16 v[56:59], a[48:51], v[144:147], v[56:59]
    ds_read_b64 v[176:177], v22 offset:40960
    v_mfma_f32_16x16x32_bf16 v[60:63], a[52:55], v[144:147], v[60:63]
    ds_read_b64 v[178:179], v23 offset:40960
    s_waitcnt lgkmcnt(12)
    v_mfma_f32_16x16x32_bf16 v[64:67], a[48:51], v[148:151], v[64:67]
    ds_read_b64 v[180:181], v22 offset:41216
    v_mfma_f32_16x16x32_bf16 v[68:71], a[52:55], v[148:151], v[68:71]
    ds_read_b64 v[182:183], v23 offset:41216
    v_mfma_f32_16x16x32_bf16 v[40:43], a[56:59], v[152:155], v[40:43]
    ds_read_b64 v[136:137], v24 offset:8192
    v_mfma_f32_16x16x32_bf16 v[44:47], a[60:63], v[152:155], v[44:47]
    ds_read_b64 v[138:139], v25 offset:8192
    s_waitcnt lgkmcnt(11)
    v_mfma_f32_16x16x32_bf16 v[48:51], a[56:59], v[156:159], v[48:51]
    ds_read_b64 v[140:141], v24 offset:8448
    v_mfma_f32_16x16x32_bf16 v[52:55], a[60:63], v[156:159], v[52:55]
    ds_read_b64 v[142:143], v25 offset:8448
    v_mfma_f32_16x16x32_bf16 v[56:59], a[56:59], v[160:163], v[56:59]
    ds_read_b64 v[144:145], v24 offset:40960
    v_mfma_f32_16x16x32_bf16 v[60:63], a[60:63], v[160:163], v[60:63]
    ds_read_b64 v[146:147], v25 offset:40960
    s_waitcnt lgkmcnt(11)
    v_mfma_f32_16x16x32_bf16 v[64:67], a[56:59], v[164:167], v[64:67]
    ds_read_b64 v[148:149], v24 offset:41216
    v_mfma_f32_16x16x32_bf16 v[68:71], a[60:63], v[164:167], v[68:71]
    ds_read_b64 v[150:151], v25 offset:41216
    s_waitcnt vmcnt(5)
    s_barrier
    v_mfma_f32_16x16x32_bf16 v[40:43], a[64:67], v[168:171], v[40:43]
    ds_read_b64 v[152:153], v26 offset:8192
    v_mfma_f32_16x16x32_bf16 v[44:47], a[68:71], v[168:171], v[44:47]
    ds_read_b64 v[154:155], v27 offset:8192
    s_waitcnt lgkmcnt(10)
    v_mfma_f32_16x16x32_bf16 v[48:51], a[64:67], v[172:175], v[48:51]
    ds_read_b64 v[156:157], v26 offset:8448
    v_mfma_f32_16x16x32_bf16 v[52:55], a[68:71], v[172:175], v[52:55]
    ds_read_b64 v[158:159], v27 offset:8448
    v_mfma_f32_16x16x32_bf16 v[56:59], a[64:67], v[176:179], v[56:59]
    ds_read_b64 v[160:161], v26 offset:40960
    v_mfma_f32_16x16x32_bf16 v[60:63], a[68:71], v[176:179], v[60:63]
    ds_read_b64 v[162:163], v27 offset:40960
    v_mfma_f32_16x16x32_bf16 v[64:67], a[64:67], v[180:183], v[64:67]
    ds_read_b64 v[164:165], v26 offset:41216
    v_mfma_f32_16x16x32_bf16 v[68:71], a[68:71], v[180:183], v[68:71]
    ds_read_b64 v[166:167], v27 offset:41216
    s_waitcnt lgkmcnt(10)
    v_mfma_f32_16x16x32_bf16 v[40:43], a[72:75], v[136:139], v[40:43]
    ds_read_b64 v[168:169], v32 offset:8192
    v_mfma_f32_16x16x32_bf16 v[44:47], a[76:79], v[136:139], v[44:47]
    ds_read_b64 v[170:171], v33 offset:8192
    v_mfma_f32_16x16x32_bf16 v[48:51], a[72:75], v[140:143], v[48:51]
    ds_read_b64 v[172:173], v32 offset:8448
    v_mfma_f32_16x16x32_bf16 v[52:55], a[76:79], v[140:143], v[52:55]
    ds_read_b64 v[174:175], v33 offset:8448
    v_mfma_f32_16x16x32_bf16 v[56:59], a[72:75], v[144:147], v[56:59]
    ds_read_b64 v[176:177], v32 offset:40960
    v_mfma_f32_16x16x32_bf16 v[60:63], a[76:79], v[144:147], v[60:63]
    ds_read_b64 v[178:179], v33 offset:40960
    s_waitcnt lgkmcnt(12)
    v_mfma_f32_16x16x32_bf16 v[64:67], a[72:75], v[148:151], v[64:67]
    ds_read_b64 v[180:181], v32 offset:41216
    v_mfma_f32_16x16x32_bf16 v[68:71], a[76:79], v[148:151], v[68:71]
    ds_read_b64 v[182:183], v33 offset:41216
    s_waitcnt vmcnt(1)
    s_barrier
    v_mfma_f32_16x16x32_bf16 v[40:43], a[80:83], v[152:155], v[40:43]
    ds_read_b64 v[136:137], v34 offset:8192
    ds_read_b64_tr_b16 a[96:97], v14 offset:32768
    v_mfma_f32_16x16x32_bf16 v[44:47], a[84:87], v[152:155], v[44:47]
    ds_read_b64 v[138:139], v35 offset:8192
    ds_read_b64_tr_b16 a[98:99], v14 offset:33792
    s_waitcnt lgkmcnt(12)
    v_mfma_f32_16x16x32_bf16 v[48:51], a[80:83], v[156:159], v[48:51]
    ds_read_b64 v[140:141], v34 offset:8448
    ds_read_b64_tr_b16 a[100:101], v15 offset:32768
    v_mfma_f32_16x16x32_bf16 v[52:55], a[84:87], v[156:159], v[52:55]
    ds_read_b64 v[142:143], v35 offset:8448
    ds_read_b64_tr_b16 a[102:103], v15 offset:33792
    v_mfma_f32_16x16x32_bf16 v[56:59], a[80:83], v[160:163], v[56:59]
    ds_read_b64 v[144:145], v34 offset:40960
    ds_read_b64_tr_b16 a[104:105], v14 offset:40960
    v_mfma_f32_16x16x32_bf16 v[60:63], a[84:87], v[160:163], v[60:63]
    ds_read_b64 v[146:147], v35 offset:40960
    ds_read_b64_tr_b16 a[106:107], v14 offset:41984
    v_mfma_f32_16x16x32_bf16 v[64:67], a[80:83], v[164:167], v[64:67]
    ds_read_b64 v[148:149], v34 offset:41216
    ds_read_b64_tr_b16 a[108:109], v15 offset:40960
    v_mfma_f32_16x16x32_bf16 v[68:71], a[84:87], v[164:167], v[68:71]
    ds_read_b64 v[150:151], v35 offset:41216
    ds_read_b64_tr_b16 a[110:111], v15 offset:41984
    s_waitcnt lgkmcnt(15)
    v_mfma_f32_16x16x32_bf16 v[40:43], a[88:91], v[168:171], v[40:43]
    ds_read_b64 v[152:153], v254 offset:8192
    ds_read_b64 v[154:155], v255 offset:8192
    v_mfma_f32_16x16x32_bf16 v[44:47], a[92:95], v[168:171], v[44:47]
    ds_read_b64 v[156:157], v254 offset:8448
    ds_read_b64 v[158:159], v255 offset:8448
    s_waitcnt lgkmcnt(15)
    v_mfma_f32_16x16x32_bf16 v[40:43], a[96:99], v[136:139], v[40:43]
    ds_read_b64 v[160:161], v254 offset:40960
    ds_read_b64 v[162:163], v255 offset:40960
    s_waitcnt lgkmcnt(14)
    v_mfma_f32_16x16x32_bf16 v[44:47], a[100:103], v[136:139], v[44:47]
    ds_read_b64 v[164:165], v254 offset:41216
    ds_read_b64 v[166:167], v255 offset:41216
    v_mfma_f32_16x16x32_bf16 v[48:51], a[88:91], v[172:175], v[48:51]
    v_mfma_f32_16x16x32_bf16 v[52:55], a[92:95], v[172:175], v[52:55]
    v_mfma_f32_16x16x32_bf16 v[48:51], a[96:99], v[140:143], v[48:51]
    v_mfma_f32_16x16x32_bf16 v[52:55], a[100:103], v[140:143], v[52:55]
    v_mfma_f32_16x16x32_bf16 v[56:59], a[88:91], v[176:179], v[56:59]
    s_waitcnt lgkmcnt(6)
    v_mfma_f32_16x16x32_bf16 v[40:43], a[104:107], v[152:155], v[40:43]
    v_mfma_f32_16x16x32_bf16 v[44:47], a[108:111], v[152:155], v[44:47]
    s_waitcnt lgkmcnt(4)
    v_mfma_f32_16x16x32_bf16 v[48:51], a[104:107], v[156:159], v[48:51]
    s_nop 4
    v_cvt_pk_bf16_f32 v40, v40, v41
    v_mfma_f32_16x16x32_bf16 v[52:55], a[108:111], v[156:159], v[52:55]
    v_cvt_pk_bf16_f32 v41, v42, v43
    v_cvt_pk_bf16_f32 v44, v44, v45
    v_mfma_f32_16x16x32_bf16 v[60:63], a[92:95], v[176:179], v[60:63]
    ds_write_b64 v236, v[40:41] offset:0
    v_mfma_f32_16x16x32_bf16 v[56:59], a[96:99], v[144:147], v[56:59]
    v_cvt_pk_bf16_f32 v45, v46, v47
    v_cvt_pk_bf16_f32 v48, v48, v49
    v_mfma_f32_16x16x32_bf16 v[60:63], a[100:103], v[144:147], v[60:63]
    ds_write_b64 v237, v[44:45] offset:0
    s_waitcnt lgkmcnt(4)
    v_mfma_f32_16x16x32_bf16 v[56:59], a[104:107], v[160:163], v[56:59]
    ds_read_b128 v[104:107], v240 offset:0
    v_mfma_f32_16x16x32_bf16 v[60:63], a[108:111], v[160:163], v[60:63]
    v_cvt_pk_bf16_f32 v49, v50, v51
    v_cvt_pk_bf16_f32 v52, v52, v53
    v_mfma_f32_16x16x32_bf16 v[64:67], a[88:91], v[180:183], v[64:67]
    ds_write_b64 v236, v[48:49] offset:1024
    v_mfma_f32_16x16x32_bf16 v[64:67], a[96:99], v[148:151], v[64:67]
    v_cvt_pk_bf16_f32 v53, v54, v55
    v_cvt_pk_bf16_f32 v56, v56, v57
    v_mfma_f32_16x16x32_bf16 v[68:71], a[92:95], v[180:183], v[68:71]
    ds_write_b64 v237, v[52:53] offset:1024
    s_waitcnt lgkmcnt(5)
    v_mfma_f32_16x16x32_bf16 v[64:67], a[104:107], v[164:167], v[64:67]
    ds_read_b128 v[108:111], v240 offset:1024
    v_mfma_f32_16x16x32_bf16 v[68:71], a[100:103], v[148:151], v[68:71]
    v_cvt_pk_bf16_f32 v57, v58, v59
    v_cvt_pk_bf16_f32 v60, v60, v61
    v_mfma_f32_16x16x32_bf16 v[68:71], a[108:111], v[164:167], v[68:71]
    ds_write_b64 v236, v[56:57] offset:2048
    v_cvt_pk_bf16_f32 v61, v62, v63
    s_waitcnt lgkmcnt(4)
    buffer_store_dwordx4 v[104:107], v241, s[44:47], s64 offen sc1
    ds_write_b64 v237, v[60:61] offset:2048
    ds_read_b128 v[112:115], v240 offset:2048
    v_cvt_pk_bf16_f32 v64, v64, v65
    v_cvt_pk_bf16_f32 v65, v66, v67
    ds_write_b64 v236, v[64:65] offset:3072
    v_cvt_pk_bf16_f32 v68, v68, v69
    v_cvt_pk_bf16_f32 v69, v70, v71
    ds_write_b64 v237, v[68:69] offset:3072
    s_waitcnt lgkmcnt(5)
    buffer_store_dwordx4 v[108:111], v241, s[44:47], s65 offen sc1
    ds_read_b128 v[116:119], v240 offset:3072
    s_waitcnt lgkmcnt(3)
    buffer_store_dwordx4 v[112:115], v241, s[44:47], s66 offen sc1
    s_waitcnt lgkmcnt(0)
    buffer_store_dwordx4 v[116:119], v241, s[44:47], s67 offen sc1
L_end:
    s_endpgm
L_repoll:
    buffer_load_dwordx2 v[232:233], v13, s[40:43], s97 offen sc1
    s_add_u32 s71, s71, 1
    s_cmp_gt_u32 s71, 0x100000
    s_cbranch_scc1 L_end
    s_nop 15
    buffer_load_dwordx2 v[246:247], v13, s[40:43], s97 offen sc1
    s_waitcnt vmcnt(1)
    v_xor_b32 v232, s58, v232
    v_xor_b32 v233, s59, v233
    v_or_b32 v232, v232, v233
    v_cmp_ne_u32 vcc, 0, v232
    s_nop 1
    s_andn2_b64 vcc, vcc, s[74:75]
    s_cbranch_vccz L_seen2
    s_waitcnt vmcnt(0)
    v_xor_b32 v246, s58, v246
    v_xor_b32 v247, s59, v247
    v_or_b32 v246, v246, v247
    v_cmp_ne_u32 vcc, 0, v246
    s_nop 1
    s_andn2_b64 vcc, vcc, s[74:75]
    s_cbranch_vccnz L_repoll
L_seen2:
    s_waitcnt vmcnt(0)
    s_branch L_seen
L_far:
    s_waitcnt vmcnt(0)
    s_nop 4
    s_add_u32 m0, s80, 114688
    s_add_u32 s57, s57, 57344
    buffer_store_dwordx4 v[104:107], v249, s[40:43], s90 offen sc1
    buffer_store_dwordx4 v[108:111], v249, s[40:43], s86 offen sc1
    buffer_store_dwordx4 v[120:123], v249, s[40:43], s96 offen sc1
    s_lshl_b32 s56, s49, 2
    s_add_u32 s56, s56, s84
    s_mul_i32 s89, s56, 114688
    s_mul_i32 s56, s48, 896
    buffer_store_dwordx4 v[124:127], v249, s[40:43], s87 offen sc1
    s_add_u32 s89, s89, s56
    s_lshl_b32 s56, s83, 2
    s_add_u32 s56, s56, s51
    s_cmp_ge_u32 s56, 14
    s_cselect_b32 s86, 0x40000000, 0
    s_lshl_b32 s56, s56, 6
    s_add_u32 s64, s89, s56
    s_add_u32 s65, s64, 28672
    s_add_u32 s66, s64, 57344
    s_add_u32 s67, s64, 86016
    s_lshl_b32 s87, s51, 12
    v_and_b32 v242, 15, v1
    s_add_u32 s87, s87, 65536
    v_lshlrev_b32 v235, 4, v242
    v_lshl_add_u32 v242, v242, 6, s87
    v_bfe_u32 v243, v1, 4, 1
    buffer_load_dwordx4 v252, s[32:35], s57 offen offset:0  lds
    v_lshl_add_u32 v242, v243, 3, v242
    v_bfe_u32 v243, v1, 1, 2
    v_lshrrev_b32 v244, 5, v1
    v_xor_b32 v243, v243, v244
    v_lshl_add_u32 v236, v243, 4, v242
    v_bfe_u32 v243, v1, 3, 2
    v_xor_b32 v243, v243, v1
    v_lshrrev_b32 v242, 2, v1
    v_and_b32 v243, 3, v243
    v_lshl_add_u32 v244, v242, 6, s87
    v_lshl_add_u32 v240, v243, 4, v244
    s_and_b32 s56, s85, 127
    v_mul_u32_u24 v242, 1792, v242
    buffer_load_dwordx4 v3, s[32:35], s57 offen offset:1024  lds
    v_and_b32 v243, 3, v1
    s_or_b32 s56, s56, s51
    v_lshl_add_u32 v242, v243, 4, v242
    s_cmp_eq_u32 s56, 0
    v_add_u32 v241, s86, v242
    s_cselect_b32 s56, 0, 0x20000000
    s_lshl_b32 s86, s48, 7
    s_or_b32 s56, s56, s86
    v_add_u32 v234, s56, v19
    s_lshl2_add_u32 s56, s52, s84
    s_lshl2_add_u32 s56, s56, s51
    s_lshl_b32 s56, s56, 14
    s_add_u32 s89, s56, 2097152
    v_and_b32 v242, 15, v1
    buffer_load_dwordx4 v4, s[32:35], s57 offen offset:2048  lds
    s_lshl_b32 s91, s51, 14
    v_xor_b32 v237, 32, v236
    v_cmp_eq_u32_e64 s[74:75], s50, v242
    v_add_u32 v20, v20, v235
    v_add_u32 v21, v21, v235
    v_add_u32 v22, v22, v235
    v_add_u32 v23, v23, v235
    v_add_u32 v24, v24, v235
    v_add_u32 v25, v25, v235
    v_add_u32 v26, v26, v235
    v_add_u32 v27, v27, v235
    v_add_u32 v32, v32, v235
    v_add_u32 v33, v33, v235
    v_add_u32 v34, v34, v235
    buffer_load_dwordx4 v5, s[32:35], s57 offen offset:3072  lds
    v_add_u32 v35, v35, v235
    v_add_u32 v254, v254, v235
    v_add_u32 v255, v255, v235
    s_mov_b32 m0, s91
    s_waitcnt vmcnt(4)
    buffer_store_dwordx2 v[38:39], v19, s[40:43], s88 offen sc1
    s_branch L_join
L_part_retryB:
    s_waitcnt vmcnt(0)
    s_add_u32 s71, s71, 1
    s_cmp_gt_u32 s71, 0x100000
    s_cbranch_scc1 L_end
    buffer_load_dwordx2 v[38:39], v13, s[40:43], s8 offen sc1
    v_xor_b32 v232, v203, v248
    v_cmp_lt_u32 vcc, 0xffff, v232
    s_nop 1
    s_cbranch_vccz L_gotB0
    buffer_load_dwordx4 v[200:203], v10, s[40:43], s5 offen offset:0 sc1
L_gotB0:
    v_xor_b32 v232, v207, v248
    v_cmp_lt_u32 vcc, 0xffff, v232
    s_nop 1
    s_cbranch_vccz L_gotB1
    buffer_load_dwordx4 v[204:207], v10, s[40:43], s5 offen offset:256 sc1
L_gotB1:
    v_xor_b32 v232, v211, v248
    v_cmp_lt_u32 vcc, 0xffff, v232
    s_nop 1
    s_cbranch_vccz L_gotB2
    buffer_load_dwordx4 v[208:211], v10, s[40:43], s5 offen offset:512 sc1
L_gotB2:
    v_xor_b32 v232, v215, v248
    v_cmp_lt_u32 vcc, 0xffff, v232
    s_nop 1
    s_cbranch_vccz L_gotB3
    buffer_load_dwordx4 v[212:215], v10, s[40:43], s5 offen offset:768 sc1
L_gotB3:
    v_xor_b32 v232, v219, v248
    v_cmp_lt_u32 vcc, 0xffff, v232
    s_nop 1
    s_cbranch_vccz L_gotB4
    buffer_load_dwordx4 v[216:219], v10, s[40:43], s6 offen offset:0 sc1
L_gotB4:
    v_xor_b32 v232, v223, v248
    v_cmp_lt_u32 vcc, 0xffff, v232
    s_nop 1
    s_cbranch_vccz L_gotB5
    buffer_load_dwordx4 v[220:223], v10, s[40:43], s6 offen offset:256 sc1
L_gotB5:
    v_xor_b32 v232, v227, v248
    v_cmp_lt_u32 vcc, 0xffff, v232
    s_nop 1
    s_cbranch_vccz L_gotB6
    buffer_load_dwordx4 v[224:227], v10, s[40:43], s6 offen offset:512 sc1
L_gotB6:
    v_xor_b32 v232, v231, v248
    v_cmp_lt_u32 vcc, 0xffff, v232
    s_nop 1
    s_cbranch_vccz L_gotB7
    buffer_load_dwordx4 v[228:231], v10, s[40:43], s6 offen offset:768 sc1
L_gotB7:
    s_waitcnt vmcnt(0)
    s_branch L_part_chkB
    .p2align 6
    .type L_tab,@object
L_tab:
    .long 0
    .long 512
    .long 1536
    .long 1032
    .long 2056
    .long 2568
    .long 3592
    .long 19456
    .long 20480
    .long 20992
    .long 22016
    .long 21512
    .long 22536
    .long 7168
    .long 8192
    .long 8704
    .long 8
    .long 520
    .long 1544
    .long 17408
    .long 18432
    .long 18944
    .long 19968
    .long 19464
    .long 20488
    .long 5120
    .long 6144
    .long 6656
    .long 7680
    .long 7176
    .long 8200
    .long 8712
    .long 16384
    .long 16896
    .long 17920
    .long 17416
    .long 18440
    .long 3072
    .long 4096
    .long 4608
    .long 5632
    .long 5128
    .long 6152
    .long 6664
    .long 7688
    .long 23552
    .long 24576
    .long 25088
    .long 16392
    .long 1024
    .long 2048
    .long 2560
    .long 3584
    .long 3080
    .long 4104
    .long 4616
    .long 5640
    .long 21504
    .long 22528
    .long 23040
    .long 24064
    .long 23560
    .long 24584
    .long 9216
    .size L_tab, 256
    .p2align 7
L_pathA:
    s_mov_b32 s88, s50
    s_mul_i32 s86, s49, 16
    s_add_u32 s86, s86, s88
    s_lshl2_add_u32 s86, s86, s51
    s_mul_i32 s87, s86, 14
    v_min_u32 v240, 13, v1
    v_add_u32 v240, s87, v240
    v_min_u32 v240, 7167, v240
    v_mul_u32_u24 v241, 9363, v240
    v_lshrrev_b32 v241, 21, v241
    v_add_u32 v241, 1, v241
    v_mul_u32_u24 v241, 28672, v241
    v_lshl_add_u32 v241, v240, 7, v241
    global_load_dword v18, v241, s[10:11]
    s_mul_i32 s87, s86, 13
    v_min_u32 v240, 12, v1
    v_add_u32 v240, s87, v240
    v_min_u32 v240, 6271, v240
    v_mul_u32_u24 v241, 9363, v240
    v_lshrrev_b32 v241, 16, v241
    v_add_u32 v241, 1, v241
    v_lshrrev_b32 v241, 1, v241
    v_mul_u32_u24 v241, 896, v241
    v_lshl_add_u32 v241, v240, 7, v241
    global_load_dword v18, v241, s[12:13]
    s_and_b32 s87, s49, 1
    s_mul_i32 s87, s87, 16
    s_add_u32 s88, s88, s87
    s_lshl2_add_u32 s88, s88, s51
    s_mul_i32 s87, s88, 14
    v_min_u32 v240, 13, v1
    v_add_u32 v240, s87, v240
    v_min_u32 v240, 1791, v240
    s_and_b32 s87, s2, 3
    s_mul_i32 s87, s87, 1792
    v_add_u32 v240, s87, v240
    v_mul_u32_u24 v241, 9363, v240
    v_lshrrev_b32 v241, 21, v241
    v_add_u32 v241, 1, v241
    v_mul_u32_u24 v241, 28672, v241
    v_lshl_add_u32 v241, v240, 7, v241
    global_load_dword v18, v241, s[4:5]
    s_load_dwordx2 s[10:11], s[22:23], 0
    s_lshl_b32 s89, s93, 7
    s_add_u32 s66, s94, s89
    s_mul_i32 s89, s93, 172032
    s_add_u32 s89, s95, s89
    s_add_u32 s74, s89, 2048
    s_add_u32 s93, s93, 1
    s_cmp_eq_u32 s93, 7
    s_cselect_b32 s93, 0, s93
    s_lshl_b32 s89, s93, 7
    s_add_u32 s67, s94, s89
    s_mul_i32 s89, s93, 172032
    s_add_u32 s89, s95, s89
    s_add_u32 s75, s89, 1024
    s_add_u32 s93, s93, 1
    s_cmp_eq_u32 s93, 7
    s_cselect_b32 s93, 0, s93
    s_lshl_b32 s89, s93, 7
    s_add_u32 s68, s94, s89
    s_mul_i32 s89, s93, 172032
    s_add_u32 s89, s95, s89
    s_add_u32 s76, s89, 4096
    s_add_u32 s93, s93, 1
    s_cmp_eq_u32 s93, 7
    s_cselect_b32 s93, 0, s93
    s_lshl_b32 s89, s93, 7
    s_add_u32 s69, s94, s89
    s_mul_i32 s89, s93, 172032
    s_add_u32 s89, s95, s89
    s_add_u32 s77, s89, 3072
    s_add_u32 s93, s93, 1
    s_cmp_eq_u32 s93, 7
    s_cselect_b32 s93, 0, s93
    v_and_b32 v235, 31, v1
    s_lshl_b32 s89, s93, 7
    v_lshrrev_b32 v236, 5, v1
    v_bfe_u32 v233, v235, 1, 3
    s_add_u32 s70, s94, s89
    s_mul_i32 s89, s93, 172032
    s_add_u32 s89, s95, s89
    s_add_u32 s78, s89, 2048
    s_add_u32 m0, s3, 98304
    v_xor_b32 v233, v233, v236
    buffer_load_dwordx4 v6, s[28:31], s74 offen offset:2048  lds
    s_add_u32 m0, s3, 98304
    v_lshl_add_u32 v234, v235, 7, s80
    buffer_load_dwordx4 v6, s[28:31], s75 offen offset:3072  lds
    s_add_u32 m0, s80, 32768
    v_xor_b32 v237, 0, v233
    buffer_load_dwordx4 v2, s[24:27], s66 offen offset:0  lds
    v_lshl_add_u32 v10, v237, 4, v234
    v_xor_b32 v237, 2, v233
    v_lshl_add_u32 v11, v237, 4, v234
    buffer_load_dwordx4 v3, s[24:27], s66 offen offset:1024  lds
    v_xor_b32 v237, 4, v233
    v_lshl_add_u32 v12, v237, 4, v234
    v_xor_b32 v237, 6, v233
    v_lshl_add_u32 v13, v237, 4, v234
    v_bfe_u32 v233, v1, 2, 2
    v_and_b32 v238, 3, v1
    v_lshlrev_b32 v234, 6, v233
    v_bfe_u32 v237, v1, 4, 1
    v_lshlrev_b32_e64 v238, 3, v238
    v_lshl_add_u32 v234, v236, 9, v234
    v_lshl_add_u32 v238, v237, 5, v238
    v_add3_u32 v7, v234, v238, s82
    v_add_u32 v8, 98304, v7
    s_mul_i32 s86, s53, 98
    s_mul_i32 s87, s51, 25
    v_min_u32 v232, 24, v1
    v_xor_b32 v237, s51, v233
    v_lshl_add_u32 v238, v237, 6, v238
    v_lshl_add_u32 v238, v233, 8, v238
    v_lshrrev_b32 v237, 4, v1
    v_lshl_add_u32 v238, v237, 11, v238
    v_add_u32 v250, 32768, v238
    v_and_b32 v255, 7, v1
    v_bfe_u32 v240, v1, 3, 2
    v_lshlrev_b32 v255, 7, v255
    v_mul_u32_u24 v237, 224, v236
    v_lshl_add_u32 v255, v240, 14, v255
    v_lshrrev_b32_e64 v240, 4, v1
    v_bfe_u32 v241, v1, 2, 2
    v_mov_b32 v234, 157696
    s_waitcnt vmcnt(8)
    s_barrier
    ds_read_b64_tr_b16 a[224:225], v8 offset:0
    ds_read_b64_tr_b16 a[226:227], v8 offset:256
    ds_read_b128 a[0:3], v10 offset:0
    ds_read_b64_tr_b16 a[228:229], v8 offset:7168
    ds_read_b64_tr_b16 a[230:231], v8 offset:7424
    ds_read_b128 a[8:11], v11 offset:0
    buffer_load_dwordx4 v4, s[24:27], s66 offen offset:2048  lds
    ds_read_b64_tr_b16 a[232:233], v8 offset:14336
    ds_read_b64_tr_b16 a[234:235], v8 offset:14592
    ds_read_b128 a[16:19], v12 offset:0
    v_xor_b32_e64 v241, v241, v240
    v_mul_u32_u24 v240, 896, v240
    v_lshl_add_u32 v240, v241, 6, v240
    ds_read_b64_tr_b16 a[236:237], v8 offset:21504
    ds_read_b64_tr_b16 a[238:239], v8 offset:21760
    ds_read_b128 a[24:27], v13 offset:0
    v_and_b32 v242, 3, v1
    v_lshl_add_u32 v240, v242, 4, v240
    v_mov_b32 v242, 0x40000000
    v_cmp_lt_u32_e64 s[60:61], 31, v1
    v_add_u32 v251, 1792, v253
    s_mov_b32 s71, 0
    s_getreg_b32 s57, hwreg(HW_REG_XCC_ID, 0, 4)
    v_add_u32 v14, 0x10000, v10
    v_add_u32 v15, 0x10000, v11
    v_add_u32 v16, 0x10000, v12
    v_add_u32 v17, 0x10000, v13
    v_cmp_eq_u32_e64 s[62:63], 28, v235
    s_waitcnt lgkmcnt(8)
    v_mfma_f32_32x32x16_bf16 v[40:55], a[224:227], a[0:3], 0
    v_mov_b32 v36, 0x3fb8aa3b
    s_waitcnt lgkmcnt(6)
    v_mfma_f32_32x32x16_bf16 v[40:55], a[228:231], a[8:11], v[40:55]
    s_waitcnt lgkmcnt(3)
    v_mfma_f32_32x32x16_bf16 v[40:55], a[232:235], a[16:19], v[40:55]
    buffer_load_dwordx4 v5, s[24:27], s66 offen offset:3072  lds
    s_add_u32 m0, s3, 102400
    s_waitcnt lgkmcnt(0)
    v_mfma_f32_32x32x16_bf16 v[40:55], a[236:239], a[24:27], v[40:55]
    s_waitcnt vmcnt(6)
    ds_read_b64_tr_b16 a[240:241], v8 offset:1024
    ds_read_b64_tr_b16 a[242:243], v8 offset:1280
    ds_read_b128 a[32:35], v10 offset:16384
    ds_read_b64_tr_b16 a[244:245], v8 offset:8192
    ds_read_b64_tr_b16 a[246:247], v8 offset:8448
    ds_read_b128 a[40:43], v11 offset:16384
    ds_read_b64_tr_b16 a[248:249], v8 offset:15360
    ds_read_b64_tr_b16 a[250:251], v8 offset:15616
    buffer_load_dwordx4 v6, s[28:31], s76 offen offset:0  lds
    s_add_u32 m0, s80, 49152
    ds_read_b128 a[48:51], v12 offset:16384
    ds_read_b64_tr_b16 a[252:253], v8 offset:22528
    ds_read_b64_tr_b16 a[254:255], v8 offset:22784
    ds_read_b128 a[56:59], v13 offset:16384
    buffer_load_dwordx4 v2, s[24:27], s67 offen offset:0  lds
    s_waitcnt lgkmcnt(9)
    v_mfma_f32_32x32x16_bf16 v[40:55], a[240:243], a[32:35], v[40:55]
    s_waitcnt lgkmcnt(6)
    v_mfma_f32_32x32x16_bf16 v[40:55], a[244:247], a[40:43], v[40:55]
    buffer_load_dwordx4 v3, s[24:27], s67 offen offset:1024  lds
    s_waitcnt lgkmcnt(3)
    v_mfma_f32_32x32x16_bf16 v[40:55], a[248:251], a[48:51], v[40:55]
    s_waitcnt lgkmcnt(0)
    v_mfma_f32_32x32x16_bf16 v[40:55], a[252:255], a[56:59], v[40:55]
    buffer_load_dwordx4 v4, s[24:27], s67 offen offset:2048  lds
    buffer_load_dwordx4 v5, s[24:27], s67 offen offset:3072  lds
    s_add_u32 m0, s3, 102400
    s_nop 0
    buffer_load_dwordx4 v6, s[28:31], s77 offen offset:1024  lds
    s_add_u32 m0, s3, 102400
    s_add_u32 s86, s86, s87
    v_add_u32 v232, s86, v232
    s_and_b32 s86, s51, 1
    s_lshl_b32 s86, s86, 4
    s_bitcmp1_b32 s51, 1
    s_cselect_b32 s82, 0x80008000, 0
    s_lshl_b32 s52, s48, 3
    s_add_u32 s52, s52, s49
    s_and_b32 s83, s50, 3
    s_lshr_b32 s84, s50, 2
    s_lshl_b32 s98, s52, 4
    s_add_u32 s85, s98, s50
    s_lshl2_add_u32 s98, s52, s51
    s_lshl_b32 s98, s98, 6
    s_add_u32 s98, s98, s50
    buffer_load_dwordx4 v6, s[28:31], s78 offen offset:2048  lds
    s_lshl_b32 s96, s98, 10
    s_add_u32 s96, s96, 2097152
    s_and_b32 s90, s50, 0
    v_min_u32 v232, 3135, v232
    s_lshl_b32 s90, s90, 15
    v_lshlrev_b32 v254, 7, v232
    v_xor_b32 v238, s86, v235
    s_add_u32 s90, s90, s96
    v_lshrrev_b32 v232, 3, v238
    v_and_b32 v233, 3, v238
    s_lshl_b32 s98, s52, 9
    v_lshl_add_u32 v232, v232, 2, v233
    s_add_u32 s98, s98, 8192
    v_lshrrev_b32 v233, 4, v238
    s_lshl_b32 s53, s51, 7
    v_sub_u32 v232, v232, v233
    s_add_u32 s53, s53, s98
    v_bfe_u32 v233, v235, 2, 1
    s_lshl_b32 s97, s84, 7
    v_mad_u32_u24 v232, v233, 14, v232
    s_add_u32 s97, s97, s98
    v_and_b32 v233, 11, v235
    s_cmp_eq_u32 s83, 3
    v_cmp_eq_u32 vcc, 11, v233
    s_cselect_b32 s98, 1, 3
    v_lshl_add_u32 v237, v232, 1, v237
    s_lshl_b32 s79, s85, 3
    v_add_u32 v237, 155648, v237
    s_add_u32 s79, s79, 4096
    v_cndmask_b32_e64 v244, v237, v234, vcc
    v_cndmask_b32_e64 v243, v232, 63, vcc
    s_lshl1_add_u32 s7, s48, 1
    v_cmp_lt_u32 vcc, s98, v241
    s_and_b32 s7, s7, s51
    s_lshl_b32 s98, s48, 4
    s_add_u32 s98, s98, s50
    v_cndmask_b32_e64 v252, v240, v242, vcc
    s_lshl2_add_u32 s98, s98, s7
    v_and_b32 v240, 1, v1
    v_and_b32 v241, 2, v1
    s_lshl_b32 s98, s98, 13
    v_cmp_eq_u32 vcc, 0, v1
    v_cmp_ne_u32_e64 s[36:37], 0, v240
    v_cmp_ne_u32_e64 s[38:39], 0, v241
    s_add_u32 s5, s98, 65536
    s_add_u32 s6, s5, 4096
    v_lshrrev_b32 v240, 3, v243
    v_bfe_u32 v241, v243, 1, 1
    s_lshl_b32 s98, s49, 10
    v_lshl_add_u32 v240, v240, 1, v241
    v_cndmask_b32_e64 v19, v242, 0, vcc
    s_add_u32 s4, s5, s98
    v_and_b32 v241, 1, v243
    s_lshl_b32 s7, s7, 10
    v_lshlrev_b32 v241, 4, v241
    v_mov_b32 v242, 0x3f80
    s_and_b32 s8, s79, 0xffffff80
    v_lshlrev_b32_e64 v242, v241, v242
    s_add_u32 s9, s80, 32768
    s_add_u32 m0, s80, 65536
    v_bfe_u32 v241, v243, 2, 1
    buffer_load_dwordx4 v2, s[24:27], s68 offen offset:0  lds
    buffer_load_dwordx4 v3, s[24:27], s68 offen offset:1024  lds
    v_cmp_eq_u32 vcc, v241, v236
    v_cndmask_b32_e64 v245, v244, v234, s[60:61]
    s_nop 0
    v_cndmask_b32_e64 v240, 15, v240, vcc
    v_cmp_eq_u32_e64 s[58:59], 0, v240
    v_cmp_eq_u32_e64 s[54:55], 1, v240
    s_nop 0
    v_cndmask_b32_e64 v20, 0, v242, s[58:59]
    buffer_load_dwordx4 v4, s[24:27], s68 offen offset:2048  lds
    v_cndmask_b32_e64 v21, 0, v242, s[54:55]
    v_cmp_eq_u32_e64 s[58:59], 2, v240
    v_cmp_eq_u32_e64 s[54:55], 3, v240
    s_nop 0
    v_cndmask_b32_e64 v22, 0, v242, s[58:59]
    v_cndmask_b32_e64 v23, 0, v242, s[54:55]
    v_cmp_eq_u32_e64 s[58:59], 4, v240
    v_cmp_eq_u32_e64 s[54:55], 5, v240
    s_nop 0
    v_cndmask_b32_e64 v24, 0, v242, s[58:59]
    v_cndmask_b32_e64 v25, 0, v242, s[54:55]
    v_cmp_eq_u32_e64 s[58:59], 6, v240
    v_cmp_eq_u32_e64 s[54:55], 7, v240
    s_nop 0
    v_cndmask_b32_e64 v26, 0, v242, s[58:59]
    v_cndmask_b32_e64 v27, 0, v242, s[54:55]
    buffer_load_dwordx4 v5, s[24:27], s68 offen offset:3072  lds
    s_add_u32 m0, s80, 81920
    s_nop 0
    buffer_load_dwordx4 v2, s[24:27], s69 offen offset:0  lds
    buffer_load_dwordx4 v3, s[24:27], s69 offen offset:1024  lds
    buffer_load_dwordx4 v4, s[24:27], s69 offen offset:2048  lds
    buffer_load_dwordx4 v5, s[24:27], s69 offen offset:3072  lds
    s_waitcnt lgkmcnt(0)
    s_waitcnt vmcnt(15)
    s_barrier
    ds_read_b64_tr_b16 a[224:225], v8 offset:2048
    ds_read_b64_tr_b16 a[226:227], v8 offset:2304
    ds_read_b128 a[64:67], v10 offset:32768
    ds_read_b64_tr_b16 a[228:229], v8 offset:9216
    ds_read_b64_tr_b16 a[230:231], v8 offset:9472
    ds_read_b128 a[72:75], v11 offset:32768
    s_add_u32 s58, s10, 0x9e3679b8
    s_add_u32 s59, s11, 0x85eaca6a
    ds_read_b64_tr_b16 a[232:233], v8 offset:16384
    ds_read_b64_tr_b16 a[234:235], v8 offset:16640
    ds_read_b128 a[80:83], v12 offset:32768
    s_or_b32 s58, s58, 0x00010001
    s_and_b32 s58, s58, 0xbfffbfff
    ds_read_b64_tr_b16 a[236:237], v8 offset:23552
    ds_read_b64_tr_b16 a[238:239], v8 offset:23808
    ds_read_b128 a[88:91], v13 offset:32768
    s_waitcnt vmcnt(10)
    ds_read_b64_tr_b16 a[240:241], v8 offset:3072
    ds_read_b64_tr_b16 a[242:243], v8 offset:3328
    ds_read_b128 a[96:99], v10 offset:49152
    s_or_b32 s59, s59, 0x00010001
    s_and_b32 s59, s59, 0xbfffbfff
    ds_read_b64_tr_b16 a[244:245], v8 offset:10240
    s_waitcnt lgkmcnt(13)
    v_mfma_f32_32x32x16_bf16 v[40:55], a[224:227], a[64:67], v[40:55]
    ds_read_b64_tr_b16 a[246:247], v8 offset:10496
    ds_read_b128 a[104:107], v11 offset:49152
    s_cmp_ge_u32 s51, 2
    ds_read_b64_tr_b16 a[248:249], v8 offset:17408
    s_waitcnt lgkmcnt(13)
    v_mfma_f32_32x32x16_bf16 v[40:55], a[228:231], a[72:75], v[40:55]
    ds_read_b64_tr_b16 a[250:251], v8 offset:17664
    ds_read_b128 a[112:115], v12 offset:49152
    s_cselect_b32 s10, 0, -1
    ds_read_b64_tr_b16 a[252:253], v8 offset:24576
    s_waitcnt lgkmcnt(13)
    v_mfma_f32_32x32x16_bf16 v[40:55], a[232:235], a[80:83], v[40:55]
    ds_read_b64_tr_b16 a[254:255], v8 offset:24832
    ds_read_b128 a[120:123], v13 offset:49152
    s_and_b32 s11, s59, 0xfffffff0
    s_or_b32 s99, s57, s11
    s_waitcnt lgkmcnt(12)
    v_mfma_f32_32x32x16_bf16 v[40:55], a[236:239], a[88:91], v[40:55]
    s_add_u32 m0, s80, 0
    v_mov_b32 v38, s58
    v_mov_b32 v39, s59
    v_cndmask_b32_e64 v246, v38, v39, s[38:39]
    v_lshlrev_b32 v247, 16, v246
    s_waitcnt lgkmcnt(8)
    v_mfma_f32_32x32x16_bf16 v[40:55], a[240:243], a[96:99], v[40:55]
    buffer_load_dwordx4 v2, s[24:27], s70 offen offset:0  lds
    buffer_load_dwordx4 v3, s[24:27], s70 offen offset:1024  lds
    buffer_load_dwordx4 v4, s[24:27], s70 offen offset:2048  lds
    s_waitcnt lgkmcnt(5)
    v_mfma_f32_32x32x16_bf16 v[40:55], a[244:247], a[104:107], v[40:55]
    buffer_load_dwordx4 v5, s[24:27], s70 offen offset:3072  lds
    s_add_u32 m0, s80, 16384
    s_add_u32 s64, s64, 28672
    v_and_b32 v246, 0xffff0000, v246
    s_waitcnt lgkmcnt(2)
    v_mfma_f32_32x32x16_bf16 v[40:55], a[248:251], a[112:115], v[40:55]
    buffer_load_dwordx4 v2, s[24:27], s64 offen offset:0  lds
    s_waitcnt vmcnt(9)
    s_barrier
    ds_read_b64_tr_b16 a[224:225], v8 offset:4096
    s_waitcnt lgkmcnt(1)
    v_mfma_f32_32x32x16_bf16 v[40:55], a[252:255], a[120:123], v[40:55]
    ds_read_b64_tr_b16 a[226:227], v8 offset:4352
    ds_read_b128 a[128:131], v14 offset:0
    ds_read_b64_tr_b16 a[228:229], v8 offset:11264
    ds_read_b64_tr_b16 a[230:231], v8 offset:11520
    ds_read_b128 a[136:139], v15 offset:0
    v_cndmask_b32_e64 v248, v247, v246, s[36:37]
    buffer_load_dwordx4 v3, s[24:27], s64 offen offset:1024  lds
    ds_read_b64_tr_b16 a[232:233], v8 offset:18432
    ds_read_b64_tr_b16 a[234:235], v8 offset:18688
    ds_read_b128 a[144:147], v16 offset:0
    v_and_b32 v248, s10, v248
    v_mov_b32_e64 v39, s99
    ds_read_b64_tr_b16 a[236:237], v8 offset:25600
    ds_read_b64_tr_b16 a[238:239], v8 offset:25856
    ds_read_b128 a[152:155], v17 offset:0
    buffer_load_dwordx4 v4, s[24:27], s64 offen offset:2048  lds
    s_waitcnt lgkmcnt(9)
    v_mfma_f32_32x32x16_bf16 v[40:55], a[224:227], a[128:131], v[40:55]
    buffer_load_dwordx4 v5, s[24:27], s64 offen offset:3072  lds
    s_waitcnt lgkmcnt(6)
    v_mfma_f32_32x32x16_bf16 v[40:55], a[228:231], a[136:139], v[40:55]
    s_add_u32 m0, s80, 32768
    s_add_u32 s65, s65, 28672
    s_waitcnt lgkmcnt(3)
    v_mfma_f32_32x32x16_bf16 v[40:55], a[232:235], a[144:147], v[40:55]
    buffer_load_dwordx4 v2, s[24:27], s65 offen offset:0  lds
    s_waitcnt lgkmcnt(0)
    v_mfma_f32_32x32x16_bf16 v[40:55], a[236:239], a[152:155], v[40:55]
    s_waitcnt vmcnt(9)
    ds_read_b64_tr_b16 a[240:241], v8 offset:5120
    ds_read_b64_tr_b16 a[242:243], v8 offset:5376
    ds_read_b128 a[160:163], v14 offset:16384
    ds_read_b64_tr_b16 a[244:245], v8 offset:12288
    ds_read_b64_tr_b16 a[246:247], v8 offset:12544
    ds_read_b128 a[168:171], v15 offset:16384
    ds_read_b64_tr_b16 a[248:249], v8 offset:19456
    ds_read_b64_tr_b16 a[250:251], v8 offset:19712
    buffer_load_dwordx4 v3, s[24:27], s65 offen offset:1024  lds
    ds_read_b128 a[176:179], v16 offset:16384
    ds_read_b64_tr_b16 a[252:253], v8 offset:26624
    ds_read_b64_tr_b16 a[254:255], v8 offset:26880
    ds_read_b128 a[184:187], v17 offset:16384
    buffer_load_dwordx4 v4, s[24:27], s65 offen offset:2048  lds
    s_waitcnt lgkmcnt(9)
    v_mfma_f32_32x32x16_bf16 v[40:55], a[240:243], a[160:163], v[40:55]
    s_waitcnt lgkmcnt(6)
    v_mfma_f32_32x32x16_bf16 v[40:55], a[244:247], a[168:171], v[40:55]
    buffer_load_dwordx4 v5, s[24:27], s65 offen offset:3072  lds
    s_add_u32 m0, s80, 49152
    s_add_u32 s66, s66, 28672
    s_waitcnt lgkmcnt(3)
    v_mfma_f32_32x32x16_bf16 v[40:55], a[248:251], a[176:179], v[40:55]
    s_waitcnt lgkmcnt(0)
    v_mfma_f32_32x32x16_bf16 v[40:55], a[252:255], a[184:187], v[40:55]
    buffer_load_dwordx4 v2, s[24:27], s66 offen offset:0  lds
    s_waitcnt vmcnt(9)
    ds_read_b64_tr_b16 a[224:225], v8 offset:6144
    buffer_load_dwordx4 v3, s[24:27], s66 offen offset:1024  lds
    ds_read_b64_tr_b16 a[226:227], v8 offset:6400
    ds_read_b128 a[192:195], v10 offset:0
    ds_read_b64_tr_b16 a[228:229], v8 offset:13312
    ds_read_b64_tr_b16 a[230:231], v8 offset:13568
    ds_read_b128 a[200:203], v11 offset:0
    ds_read_b64_tr_b16 a[232:233], v8 offset:20480
    ds_read_b64_tr_b16 a[234:235], v8 offset:20736
    ds_read_b128 a[208:211], v12 offset:0
    buffer_load_dwordx4 v4, s[24:27], s66 offen offset:2048  lds
    ds_read_b64_tr_b16 a[236:237], v8 offset:27648
    ds_read_b64_tr_b16 a[238:239], v8 offset:27904
    ds_read_b128 a[216:219], v13 offset:0
    buffer_load_dwordx4 v5, s[24:27], s66 offen offset:3072  lds
    s_waitcnt lgkmcnt(9)
    v_mfma_f32_32x32x16_bf16 v[40:55], a[224:227], a[192:195], v[40:55]
    s_add_u32 m0, s80, 65536
    s_add_u32 s67, s67, 28672
    s_waitcnt lgkmcnt(6)
    v_mfma_f32_32x32x16_bf16 v[40:55], a[228:231], a[200:203], v[40:55]
    buffer_load_dwordx4 v2, s[24:27], s67 offen offset:0  lds
    s_waitcnt lgkmcnt(3)
    v_mfma_f32_32x32x16_bf16 v[40:55], a[232:235], a[208:211], v[40:55]
    s_waitcnt lgkmcnt(0)
    v_mfma_f32_32x32x16_bf16 v[40:55], a[236:239], a[216:219], v[40:55]
    buffer_load_dwordx4 v3, s[24:27], s67 offen offset:1024  lds
    buffer_load_dwordx4 v4, s[24:27], s67 offen offset:2048  lds
    buffer_load_dwordx4 v5, s[24:27], s67 offen offset:3072  lds
    s_add_u32 m0, s80, 81920
    s_add_u32 s68, s68, 28672
    s_waitcnt vmcnt(12)
    ds_read_b64_tr_b16 a[240:241], v8 offset:0
    ds_read_b64_tr_b16 a[242:243], v8 offset:256
    ds_read_b128 a[4:7], v10 offset:16384
    ds_read_b64_tr_b16 a[244:245], v8 offset:7168
    ds_read_b64_tr_b16 a[246:247], v8 offset:7424
    ds_read_b128 a[12:15], v11 offset:16384
    v_cvt_pk_bf16_f32 v40, v40, v41
    v_cvt_pk_bf16_f32 v41, v42, v43
    v_cvt_pk_bf16_f32 v42, v44, v45
    ds_read_b64_tr_b16 a[248:249], v8 offset:14336
    ds_read_b64_tr_b16 a[250:251], v8 offset:14592
    ds_read_b128 a[20:23], v12 offset:16384
    v_cvt_pk_bf16_f32 v43, v46, v47
    v_cvt_pk_bf16_f32 v46, v52, v53
    v_cvt_pk_bf16_f32 v47, v54, v55
    v_mfma_f32_32x32x16_bf16 v[104:119], v[40:43], v[20:23], 0
    ds_read_b64_tr_b16 a[252:253], v8 offset:21504
    ds_read_b64_tr_b16 a[254:255], v8 offset:21760
    ds_read_b128 a[28:31], v13 offset:16384
    buffer_load_dwordx4 v2, s[24:27], s68 offen offset:0  lds
    v_cvt_pk_bf16_f32 v44, v48, v49
    v_cvt_pk_bf16_f32 v45, v50, v51
    v_cndmask_b32_e64 v46, v46, 0, s[60:61]
    s_waitcnt vmcnt(9)
    v_cndmask_b32_e64 v47, v47, 0, s[60:61]
    s_nop 1
    v_mfma_f32_32x32x16_bf16 v[104:119], v[44:47], v[24:27], v[104:119]
    buffer_load_dwordx4 v3, s[24:27], s68 offen offset:1024  lds
    ds_read_b64_tr_b16 a[224:225], v8 offset:1024
    ds_read_b64_tr_b16 a[226:227], v8 offset:1280
    ds_read_b128 a[36:39], v10 offset:32768
    ds_read_b64_tr_b16 a[228:229], v8 offset:8192
    s_waitcnt lgkmcnt(10)
    v_mfma_f32_32x32x16_bf16 v[56:71], a[240:243], a[4:7], 0
    ds_read_b64_tr_b16 a[230:231], v8 offset:8448
    ds_read_b128 a[44:47], v11 offset:32768
    ds_read_b64_tr_b16 a[232:233], v8 offset:15360
    buffer_load_dwordx4 v4, s[24:27], s68 offen offset:2048  lds
    v_mfma_f32_32x32x16_bf16 v[56:71], a[244:247], a[12:15], v[56:71]
    ds_read_b64_tr_b16 a[234:235], v8 offset:15616
    ds_read_b128 a[52:55], v12 offset:32768
    ds_read_b64_tr_b16 a[236:237], v8 offset:22528
    ds_read_b64_tr_b16 a[238:239], v8 offset:22784
    s_waitcnt lgkmcnt(11)
    v_mfma_f32_32x32x16_bf16 v[56:71], a[248:251], a[20:23], v[56:71]
    ds_read_b128 a[60:63], v13 offset:32768
    v_mul_f32 v136, v36, v104
    v_mul_f32 v137, v36, v105
    v_exp_f32_e64 v136, v136 clamp
    v_mfma_f32_32x32x16_bf16 v[56:71], a[252:255], a[28:31], v[56:71]
    buffer_load_dwordx4 v5, s[24:27], s68 offen offset:3072  lds
    s_add_u32 m0, s80, 0
    s_add_u32 s69, s69, 28672
    v_exp_f32_e64 v137, v137 clamp
    s_waitcnt lgkmcnt(9)
    v_mfma_f32_32x32x16_bf16 v[56:71], a[224:227], a[36:39], v[56:71]
    v_mul_f32 v138, v36, v106
    v_mul_f32 v139, v36, v107
    v_exp_f32_e64 v138, v138 clamp
    v_exp_f32_e64 v139, v139 clamp
    s_waitcnt lgkmcnt(6)
    v_mfma_f32_32x32x16_bf16 v[56:71], a[228:231], a[44:47], v[56:71]
    buffer_load_dwordx4 v2, s[24:27], s69 offen offset:0  lds
    v_mul_f32 v140, v36, v108
    v_mul_f32 v141, v36, v109
    v_mul_f32 v142, v36, v110
    s_waitcnt lgkmcnt(2)
    v_mfma_f32_32x32x16_bf16 v[56:71], a[232:235], a[52:55], v[56:71]
    v_mul_f32 v143, v36, v111
    v_max_f32 v104, 0x358637bd, v104
    v_max_f32 v105, 0x358637bd, v105
    v_exp_f32_e64 v140, v140 clamp
    s_waitcnt lgkmcnt(0)
    v_mfma_f32_32x32x16_bf16 v[56:71], a[236:239], a[60:63], v[56:71]
    buffer_load_dwordx4 v3, s[24:27], s69 offen offset:1024  lds
    s_waitcnt vmcnt(10)
    ds_read_b64_tr_b16 a[240:241], v8 offset:2048
    ds_read_b64_tr_b16 a[242:243], v8 offset:2304
    ds_read_b128 a[68:71], v10 offset:49152
    ds_read_b64_tr_b16 a[244:245], v8 offset:9216
    ds_read_b64_tr_b16 a[246:247], v8 offset:9472
    ds_read_b128 a[76:79], v11 offset:49152
    v_exp_f32_e64 v141, v141 clamp
    v_exp_f32_e64 v142, v142 clamp
    ds_read_b64_tr_b16 a[248:249], v8 offset:16384
    buffer_load_dwordx4 v4, s[24:27], s69 offen offset:2048  lds
    ds_read_b64_tr_b16 a[250:251], v8 offset:16640
    ds_read_b128 a[84:87], v12 offset:49152
    ds_read_b64_tr_b16 a[252:253], v8 offset:23552
    ds_read_b64_tr_b16 a[254:255], v8 offset:23808
    ds_read_b128 a[92:95], v13 offset:49152
    v_exp_f32_e64 v143, v143 clamp
    v_add_f32 v136, v136, v104
    v_add_f32 v137, v137, v105
    v_max_f32 v106, 0x358637bd, v106
    v_max_f32 v107, 0x358637bd, v107
    v_cvt_pk_bf16_f32 v136, v136, v137
    v_add_f32 v138, v138, v106
    v_add_f32 v139, v139, v107
    v_max_f32 v108, 0x358637bd, v108
    v_max_f32 v109, 0x358637bd, v109
    s_waitcnt lgkmcnt(9)
    v_mfma_f32_32x32x16_bf16 v[56:71], a[240:243], a[68:71], v[56:71]
    buffer_load_dwordx4 v5, s[24:27], s69 offen offset:3072  lds
    s_add_u32 m0, s80, 16384
    s_add_u32 s70, s70, 28672
    v_max_f32 v110, 0x358637bd, v110
    s_waitcnt lgkmcnt(6)
    v_mfma_f32_32x32x16_bf16 v[56:71], a[244:247], a[76:79], v[56:71]
    v_max_f32 v111, 0x358637bd, v111
    v_cvt_pk_bf16_f32 v137, v138, v139
    v_add_f32 v140, v140, v108
    v_add_f32 v141, v141, v109
    v_add_f32 v142, v142, v110
    s_waitcnt lgkmcnt(1)
    v_mfma_f32_32x32x16_bf16 v[56:71], a[248:251], a[84:87], v[56:71]
    buffer_load_dwordx4 v2, s[24:27], s70 offen offset:0  lds
    v_add_f32 v143, v143, v111
    v_cvt_pk_bf16_f32 v138, v140, v141
    v_cvt_pk_bf16_f32 v139, v142, v143
    s_waitcnt lgkmcnt(0)
    v_mfma_f32_32x32x16_bf16 v[56:71], a[252:255], a[92:95], v[56:71]
    v_mul_f32_e64 v144, v36, v112
    s_waitcnt vmcnt(9)
    buffer_load_dwordx4 v3, s[24:27], s70 offen offset:1024  lds
    ds_read_b64_tr_b16 a[224:225], v8 offset:3072
    ds_read_b64_tr_b16 a[226:227], v8 offset:3328
    ds_read_b128 a[100:103], v14 offset:0
    ds_read_b64_tr_b16 a[228:229], v8 offset:10240
    ds_read_b64_tr_b16 a[230:231], v8 offset:10496
    ds_read_b128 a[108:111], v15 offset:0
    v_mul_f32 v145, v36, v113
    v_mul_f32 v146, v36, v114
    v_mul_f32_e64 v147, v36, v115
    ds_read_b64_tr_b16 a[232:233], v8 offset:17408
    ds_read_b64_tr_b16 a[234:235], v8 offset:17664
    ds_read_b128 a[116:119], v16 offset:0
    buffer_load_dwordx4 v4, s[24:27], s70 offen offset:2048  lds
    ds_read_b64_tr_b16 a[236:237], v8 offset:24576
    ds_read_b64_tr_b16 a[238:239], v8 offset:24832
    ds_read_b128 a[124:127], v17 offset:0
    v_mul_f32 v148, v36, v116
    v_mul_f32 v149, v36, v117
    v_mul_f32 v150, v36, v118
    v_mul_f32_e64 v151, v36, v119
    v_exp_f32_e64 v144, v144 clamp
    v_exp_f32_e64 v145, v145 clamp
    v_exp_f32_e64 v146, v146 clamp
    v_exp_f32_e64 v147, v147 clamp
    s_waitcnt lgkmcnt(9)
    v_mfma_f32_32x32x16_bf16 v[56:71], a[224:227], a[100:103], v[56:71]
    buffer_load_dwordx4 v5, s[24:27], s70 offen offset:3072  lds
    s_add_u32 m0, s3, 126976
    v_exp_f32_e64 v148, v148 clamp
    s_waitcnt lgkmcnt(6)
    v_mfma_f32_32x32x16_bf16 v[56:71], a[228:231], a[108:111], v[56:71]
    v_exp_f32_e64 v149, v149 clamp
    v_exp_f32_e64 v150, v150 clamp
    v_exp_f32_e64 v151, v151 clamp
    s_waitcnt lgkmcnt(3)
    v_mfma_f32_32x32x16_bf16 v[56:71], a[232:235], a[116:119], v[56:71]
    buffer_load_dwordx4 v251, s[28:31], s72 offen offset:0  lds
    v_max_f32 v112, 0x358637bd, v112
    v_max_f32 v113, 0x358637bd, v113
    v_max_f32 v114, 0x358637bd, v114
    s_waitcnt lgkmcnt(0)
    v_mfma_f32_32x32x16_bf16 v[56:71], a[236:239], a[124:127], v[56:71]
    v_max_f32 v115, 0x358637bd, v115
    v_max_f32 v116, 0x358637bd, v116
    v_max_f32 v117, 0x358637bd, v117
    v_max_f32 v118, 0x358637bd, v118
    s_waitcnt vmcnt(9)
    buffer_load_dwordx4 v251, s[28:31], s73 offen offset:1024  lds
    ds_read_b64_tr_b16 a[240:241], v8 offset:4096
    ds_read_b64_tr_b16 a[242:243], v8 offset:4352
    ds_read_b128 a[132:135], v14 offset:16384
    ds_read_b64_tr_b16 a[244:245], v8 offset:11264
    ds_read_b64_tr_b16 a[246:247], v8 offset:11520
    ds_read_b128 a[140:143], v15 offset:16384
    v_max_f32 v119, 0x358637bd, v119
    v_add_f32 v144, v144, v112
    v_add_f32 v145, v145, v113
    ds_read_b64_tr_b16 a[248:249], v8 offset:18432
    ds_read_b64_tr_b16 a[250:251], v8 offset:18688
    buffer_load_dwordx4 v251, s[28:31], s74 offen offset:2048  lds
    ds_read_b128 a[148:151], v16 offset:16384
    ds_read_b64_tr_b16 a[252:253], v8 offset:25600
    ds_read_b64_tr_b16 a[254:255], v8 offset:25856
    ds_read_b128 a[156:159], v17 offset:16384
    v_mov_b32 v17, 0x3f803f80
    v_add_f32 v146, v146, v114
    v_add_f32 v147, v147, v115
    v_add_f32 v148, v148, v116
    v_add_f32 v149, v149, v117
    v_add_f32 v150, v150, v118
    v_add_f32 v151, v151, v119
    v_cvt_pk_bf16_f32 v140, v144, v145
    v_cvt_pk_bf16_f32 v141, v146, v147
    v_cvt_pk_bf16_f32 v142, v148, v149
    v_cvt_pk_bf16_f32 v143, v150, v151
    v_mov_b32 v2, 0xffff
    s_waitcnt lgkmcnt(8)
    v_mfma_f32_32x32x16_bf16 v[56:71], a[240:243], a[132:135], v[56:71]
    buffer_load_dwordx4 v251, s[28:31], s75 offen offset:3072  lds
    s_add_u32 m0, s3, 131072
    s_waitcnt lgkmcnt(6)
    v_mfma_f32_32x32x16_bf16 v[56:71], a[244:247], a[140:143], v[56:71]
    s_waitcnt lgkmcnt(3)
    v_mfma_f32_32x32x16_bf16 v[56:71], a[248:251], a[148:151], v[56:71]
    s_waitcnt lgkmcnt(0)
    v_mfma_f32_32x32x16_bf16 v[56:71], a[252:255], a[156:159], v[56:71]
    s_waitcnt vmcnt(8)
    ds_read_b64_tr_b16 a[224:225], v8 offset:5120
    ds_read_b64_tr_b16 a[226:227], v8 offset:5376
    ds_read_b128 a[164:167], v10 offset:0
    ds_read_b64_tr_b16 a[228:229], v8 offset:12288
    ds_read_b64_tr_b16 a[230:231], v8 offset:12544
    ds_read_b128 a[172:175], v11 offset:0
    buffer_load_dwordx4 v251, s[28:31], s76 offen offset:0  lds
    ds_read_b64_tr_b16 a[232:233], v8 offset:19456
    ds_read_b64_tr_b16 a[234:235], v8 offset:19712
    ds_read_b128 a[180:183], v12 offset:0
    ds_read_b64_tr_b16 a[236:237], v8 offset:26624
    ds_read_b64_tr_b16 a[238:239], v8 offset:26880
    ds_read_b128 a[188:191], v13 offset:0
    s_waitcnt lgkmcnt(9)
    v_mfma_f32_32x32x16_bf16 v[56:71], a[224:227], a[164:167], v[56:71]
    s_waitcnt lgkmcnt(6)
    v_mfma_f32_32x32x16_bf16 v[56:71], a[228:231], a[172:175], v[56:71]
    s_waitcnt lgkmcnt(3)
    v_mfma_f32_32x32x16_bf16 v[56:71], a[232:235], a[180:183], v[56:71]
    buffer_load_dwordx4 v251, s[28:31], s77 offen offset:1024  lds
    s_waitcnt lgkmcnt(0)
    v_mfma_f32_32x32x16_bf16 v[56:71], a[236:239], a[188:191], v[56:71]
    s_waitcnt vmcnt(6)
    ds_read_b64_tr_b16 a[240:241], v8 offset:6144
    ds_read_b64_tr_b16 a[242:243], v8 offset:6400
    ds_read_b128 a[196:199], v10 offset:16384
    ds_read_b64_tr_b16 a[244:245], v8 offset:13312
    ds_read_b64_tr_b16 a[246:247], v8 offset:13568
    ds_read_b128 a[204:207], v11 offset:16384
    v_add_u32_e64 v10, s9, v249
    v_xor_b32 v11, 4096, v10
    ds_read_b64_tr_b16 a[248:249], v8 offset:20480
    ds_read_b64_tr_b16 a[250:251], v8 offset:20736
    ds_read_b128 a[212:215], v12 offset:16384
    v_xor_b32 v12, 8192, v10
    ds_read_b64_tr_b16 a[252:253], v8 offset:27648
    ds_read_b64_tr_b16 a[254:255], v8 offset:27904
    ds_read_b128 a[220:223], v13 offset:16384
    v_xor_b32 v13, 12288, v10
    s_waitcnt lgkmcnt(9)
    v_mfma_f32_32x32x16_bf16 v[56:71], a[240:243], a[196:199], v[56:71]
    buffer_load_dwordx4 v251, s[28:31], s78 offen offset:2048  lds
    s_add_u32 m0, s3, 0
    s_waitcnt lgkmcnt(6)
    v_mfma_f32_32x32x16_bf16 v[56:71], a[244:247], a[204:207], v[56:71]
    s_waitcnt lgkmcnt(3)
    v_mfma_f32_32x32x16_bf16 v[56:71], a[248:251], a[212:215], v[56:71]
    s_waitcnt lgkmcnt(0)
    s_waitcnt vmcnt(6)
    s_barrier
    ds_read_b64_tr_b16 a[224:225], v8 offset:28672
    v_mfma_f32_32x32x16_bf16 v[56:71], a[252:255], a[220:223], v[56:71]
    ds_read_b64_tr_b16 a[226:227], v8 offset:28928
    ds_read_b64_tr_b16 a[228:229], v8 offset:35840
    ds_read_b64_tr_b16 a[230:231], v8 offset:36096
    ds_read_b64_tr_b16 a[232:233], v8 offset:43008
    ds_read_b64_tr_b16 a[234:235], v8 offset:43264
    ds_read_b64_tr_b16 a[236:237], v8 offset:50176
    ds_read_b64_tr_b16 a[238:239], v8 offset:50432
    s_nop 4
    v_cvt_pk_bf16_f32 v56, v56, v57
    v_cvt_pk_bf16_f32 v57, v58, v59
    v_cvt_pk_bf16_f32 v58, v60, v61
    v_cvt_pk_bf16_f32 v59, v62, v63
    v_cvt_pk_bf16_f32 v62, v68, v69
    v_cvt_pk_bf16_f32 v63, v70, v71
    v_mfma_f32_32x32x16_bf16 v[120:135], v[56:59], v[20:23], 0
    v_cvt_pk_bf16_f32 v60, v64, v65
    v_cvt_pk_bf16_f32 v61, v66, v67
    v_cndmask_b32_e64 v62, v62, 0, s[60:61]
    v_cndmask_b32_e64 v63, v63, 0, s[60:61]
    s_nop 1
    v_mfma_f32_32x32x16_bf16 v[120:135], v[60:63], v[24:27], v[120:135]
    buffer_load_dwordx4 v253, s[28:31], s72 offen offset:0  lds
    s_waitcnt lgkmcnt(6)
    v_mfma_f32_32x32x16_bf16 v[72:87], a[0:3], a[224:227], 0
    s_waitcnt vmcnt(6)
    s_barrier
    ds_read_b64_tr_b16 a[240:241], v8 offset:29696
    ds_read_b64_tr_b16 a[242:243], v8 offset:29952
    ds_read_b64_tr_b16 a[244:245], v8 offset:36864
    s_waitcnt lgkmcnt(5)
    v_mfma_f32_32x32x16_bf16 v[72:87], a[8:11], a[228:231], v[72:87]
    ds_read_b64_tr_b16 a[246:247], v8 offset:37120
    ds_read_b64_tr_b16 a[248:249], v8 offset:44032
    ds_read_b64_tr_b16 a[250:251], v8 offset:44288
    ds_read_b64_tr_b16 a[252:253], v8 offset:51200
    ds_read_b64_tr_b16 a[254:255], v8 offset:51456
    v_mfma_f32_32x32x16_bf16 v[88:103], a[4:7], a[224:227], 0
    v_mul_f32 v168, v36, v120
    v_mul_f32 v169, v36, v121
    v_exp_f32_e64 v168, v168 clamp
    v_exp_f32_e64 v169, v169 clamp
    v_mfma_f32_32x32x16_bf16 v[72:87], a[16:19], a[232:235], v[72:87]
    v_mul_f32 v170, v36, v122
    v_mul_f32 v171, v36, v123
    v_exp_f32_e64 v170, v170 clamp
    v_exp_f32_e64 v171, v171 clamp
    v_mfma_f32_32x32x16_bf16 v[88:103], a[12:15], a[228:231], v[88:103]
    v_mul_f32 v172, v36, v124
    v_mul_f32 v173, v36, v125
    v_mul_f32 v174, v36, v126
    v_mul_f32 v175, v36, v127
    v_max_f32 v120, 0x358637bd, v120
    v_max_f32 v121, 0x358637bd, v121
    s_waitcnt lgkmcnt(5)
    v_mfma_f32_32x32x16_bf16 v[72:87], a[24:27], a[236:239], v[72:87]
    buffer_load_dwordx4 v253, s[28:31], s73 offen offset:1024  lds
    v_exp_f32_e64 v172, v172 clamp
    v_exp_f32_e64 v173, v173 clamp
    v_mfma_f32_32x32x16_bf16 v[88:103], a[20:23], a[232:235], v[88:103]
    v_exp_f32_e64 v174, v174 clamp
    s_waitcnt vmcnt(6)
    s_barrier
    ds_read_b64_tr_b16 a[224:225], v8 offset:30720
    ds_read_b64_tr_b16 a[226:227], v8 offset:30976
    v_mfma_f32_32x32x16_bf16 v[72:87], a[32:35], a[240:243], v[72:87]
    ds_read_b64_tr_b16 a[228:229], v8 offset:37888
    ds_read_b64_tr_b16 a[230:231], v8 offset:38144
    ds_read_b64_tr_b16 a[232:233], v8 offset:45056
    ds_read_b64_tr_b16 a[234:235], v8 offset:45312
    v_exp_f32_e64 v175, v175 clamp
    v_mfma_f32_32x32x16_bf16 v[88:103], a[28:31], a[236:239], v[88:103]
    ds_read_b64_tr_b16 a[236:237], v8 offset:52224
    ds_read_b64_tr_b16 a[238:239], v8 offset:52480
    v_add_f32 v168, v168, v120
    v_add_f32 v169, v169, v121
    v_max_f32 v122, 0x358637bd, v122
    v_max_f32 v123, 0x358637bd, v123
    s_waitcnt lgkmcnt(8)
    v_mfma_f32_32x32x16_bf16 v[72:87], a[40:43], a[244:247], v[72:87]
    v_cvt_pk_bf16_f32 v168, v168, v169
    v_add_f32 v170, v170, v122
    v_add_f32_e64 v171, v171, v123
    v_max_f32 v124, 0x358637bd, v124
    v_max_f32 v125, 0x358637bd, v125
    v_mfma_f32_32x32x16_bf16 v[88:103], a[36:39], a[240:243], v[88:103]
    v_max_f32 v126, 0x358637bd, v126
    v_max_f32 v127, 0x358637bd, v127
    v_cvt_pk_bf16_f32 v169, v170, v171
    v_add_f32 v172, v172, v124
    v_add_f32 v173, v173, v125
    v_add_f32 v174, v174, v126
    v_mfma_f32_32x32x16_bf16 v[72:87], a[48:51], a[248:251], v[72:87]
    buffer_load_dwordx4 v253, s[28:31], s74 offen offset:2048  lds
    v_add_f32 v175, v175, v127
    v_cvt_pk_bf16_f32 v170, v172, v173
    v_cvt_pk_bf16_f32 v171, v174, v175
    v_mfma_f32_32x32x16_bf16 v[88:103], a[44:47], a[244:247], v[88:103]
    v_mul_f32 v176, v36, v128
    v_mul_f32 v177, v36, v129
    v_mul_f32 v178, v36, v130
    v_mul_f32 v179, v36, v131
    v_mul_f32 v180, v36, v132
    v_mul_f32 v181, v36, v133
    v_mfma_f32_32x32x16_bf16 v[72:87], a[56:59], a[252:255], v[72:87]
    v_mul_f32 v182, v36, v134
    v_mul_f32 v183, v36, v135
    v_exp_f32_e64 v176, v176 clamp
    v_exp_f32_e64 v177, v177 clamp
    v_mfma_f32_32x32x16_bf16 v[88:103], a[52:55], a[248:251], v[88:103]
    v_exp_f32_e64 v178, v178 clamp
    v_exp_f32_e64 v179, v179 clamp
    v_exp_f32_e64 v180, v180 clamp
    s_waitcnt lgkmcnt(0)
    v_mfma_f32_32x32x16_bf16 v[72:87], a[64:67], a[224:227], v[72:87]
    v_exp_f32_e64 v181, v181 clamp
    v_exp_f32_e64 v182, v182 clamp
    v_exp_f32_e64 v183, v183 clamp
    v_mfma_f32_32x32x16_bf16 v[88:103], a[60:63], a[252:255], v[88:103]
    v_max_f32 v128, 0x358637bd, v128
    v_max_f32 v129, 0x358637bd, v129
    v_max_f32 v130, 0x358637bd, v130
    v_max_f32 v131, 0x358637bd, v131
    v_max_f32 v132, 0x358637bd, v132
    v_max_f32 v133, 0x358637bd, v133
    v_mfma_f32_32x32x16_bf16 v[72:87], a[72:75], a[228:231], v[72:87]
    buffer_load_dwordx4 v253, s[28:31], s75 offen offset:3072  lds
    s_add_u32 m0, s3, 4096
    v_max_f32 v134, 0x358637bd, v134
    v_max_f32 v135, 0x358637bd, v135
    v_mfma_f32_32x32x16_bf16 v[88:103], a[68:71], a[224:227], v[88:103]
    v_add_f32 v176, v176, v128
    s_waitcnt vmcnt(6)
    s_barrier
    ds_read_b64_tr_b16 a[240:241], v8 offset:31744
    ds_read_b64_tr_b16 a[242:243], v8 offset:32000
    ds_read_b64_tr_b16 a[244:245], v8 offset:38912
    v_mfma_f32_32x32x16_bf16 v[72:87], a[80:83], a[232:235], v[72:87]
    ds_read_b64_tr_b16 a[246:247], v8 offset:39168
    ds_read_b64_tr_b16 a[248:249], v8 offset:46080
    ds_read_b64_tr_b16 a[250:251], v8 offset:46336
    ds_read_b64_tr_b16 a[252:253], v8 offset:53248
    ds_read_b64_tr_b16 a[254:255], v8 offset:53504
    v_mfma_f32_32x32x16_bf16 v[88:103], a[76:79], a[228:231], v[88:103]
    ds_read_b64_tr_b16 a[224:225], v8 offset:32768
    ds_read_b64_tr_b16 a[226:227], v8 offset:33024
    ds_read_b64_tr_b16 a[228:229], v8 offset:39936
    ds_read_b64_tr_b16 a[230:231], v8 offset:40192
    v_add_f32 v177, v177, v129
    v_add_f32 v178, v178, v130
    v_mfma_f32_32x32x16_bf16 v[72:87], a[88:91], a[236:239], v[72:87]
    v_add_f32 v179, v179, v131
    v_add_f32 v180, v180, v132
    v_add_f32 v181, v181, v133
    v_add_f32 v182, v182, v134
    v_add_f32_e64 v183, v183, v135
    v_mfma_f32_32x32x16_bf16 v[88:103], a[84:87], a[232:235], v[88:103]
    ds_read_b64_tr_b16 a[232:233], v8 offset:47104
    ds_read_b64_tr_b16 a[234:235], v8 offset:47360
    v_cvt_pk_bf16_f32 v172, v176, v177
    v_cvt_pk_bf16_f32 v173, v178, v179
    v_cvt_pk_bf16_f32 v174, v180, v181
    v_cvt_pk_bf16_f32 v175, v182, v183
    s_waitcnt lgkmcnt(10)
    v_mfma_f32_32x32x16_bf16 v[72:87], a[96:99], a[240:243], v[72:87]
    buffer_load_dwordx4 v253, s[28:31], s76 offen offset:0  lds
    s_cmp_ge_u32 s51, 2
    s_cselect_b32 s86, 0x40000000, 0
    v_add_u32 v16, s86, v249
    v_mfma_f32_32x32x16_bf16 v[88:103], a[92:95], a[236:239], v[88:103]
    ds_read_b64_tr_b16 a[236:237], v8 offset:54272
    ds_read_b64_tr_b16 a[238:239], v8 offset:54528
    v_mfma_f32_32x32x16_bf16 v[72:87], a[104:107], a[244:247], v[72:87]
    v_mfma_f32_32x32x16_bf16 v[88:103], a[100:103], a[240:243], v[88:103]
    s_waitcnt lgkmcnt(4)
    v_mfma_f32_32x32x16_bf16 v[72:87], a[112:115], a[248:251], v[72:87]
    v_mfma_f32_32x32x16_bf16 v[88:103], a[108:111], a[244:247], v[88:103]
    v_mfma_f32_32x32x16_bf16 v[72:87], a[120:123], a[252:255], v[72:87]
    buffer_load_dwordx4 v253, s[28:31], s77 offen offset:1024  lds
    v_mfma_f32_32x32x16_bf16 v[88:103], a[116:119], a[248:251], v[88:103]
    s_waitcnt vmcnt(6)
    s_barrier
    ds_read_b64_tr_b16 a[240:241], v8 offset:33792
    v_mfma_f32_32x32x16_bf16 v[72:87], a[128:131], a[224:227], v[72:87]
    ds_read_b64_tr_b16 a[242:243], v8 offset:34048
    ds_read_b64_tr_b16 a[244:245], v8 offset:40960
    ds_read_b64_tr_b16 a[246:247], v8 offset:41216
    ds_read_b64_tr_b16 a[248:249], v8 offset:48128
    ds_read_b64_tr_b16 a[250:251], v8 offset:48384
    v_mfma_f32_32x32x16_bf16 v[88:103], a[124:127], a[252:255], v[88:103]
    ds_read_b64_tr_b16 a[252:253], v8 offset:55296
    ds_read_b64_tr_b16 a[254:255], v8 offset:55552
    v_mfma_f32_32x32x16_bf16 v[72:87], a[136:139], a[228:231], v[72:87]
    v_mfma_f32_32x32x16_bf16 v[88:103], a[132:135], a[224:227], v[88:103]
    ds_read_b64_tr_b16 a[224:225], v8 offset:34816
    ds_read_b64_tr_b16 a[226:227], v8 offset:35072
    s_waitcnt lgkmcnt(10)
    v_mfma_f32_32x32x16_bf16 v[72:87], a[144:147], a[232:235], v[72:87]
    buffer_load_dwordx4 v253, s[28:31], s78 offen offset:2048  lds
    v_mfma_f32_32x32x16_bf16 v[88:103], a[140:143], a[228:231], v[88:103]
    ds_read_b64_tr_b16 a[228:229], v8 offset:41984
    ds_read_b64_tr_b16 a[230:231], v8 offset:42240
    v_mfma_f32_32x32x16_bf16 v[72:87], a[152:155], a[236:239], v[72:87]
    v_mfma_f32_32x32x16_bf16 v[88:103], a[148:151], a[232:235], v[88:103]
    ds_read_b64_tr_b16 a[232:233], v8 offset:49152
    ds_read_b64_tr_b16 a[234:235], v8 offset:49408
    s_waitcnt lgkmcnt(12)
    v_mfma_f32_32x32x16_bf16 v[72:87], a[160:163], a[240:243], v[72:87]
    v_mfma_f32_32x32x16_bf16 v[88:103], a[156:159], a[236:239], v[88:103]
    ds_read_b64_tr_b16 a[236:237], v8 offset:56320
    ds_read_b64_tr_b16 a[238:239], v8 offset:56576
    s_waitcnt lgkmcnt(12)
    v_mfma_f32_32x32x16_bf16 v[72:87], a[168:171], a[244:247], v[72:87]
    buffer_load_dword v18, v254, s[32:35], 0 offen
    v_mfma_f32_32x32x16_bf16 v[88:103], a[164:167], a[240:243], v[88:103]
    s_waitcnt lgkmcnt(9)
    v_mfma_f32_32x32x16_bf16 v[72:87], a[176:179], a[248:251], v[72:87]
    v_mfma_f32_32x32x16_bf16 v[88:103], a[172:175], a[244:247], v[88:103]
    s_waitcnt lgkmcnt(8)
    v_mfma_f32_32x32x16_bf16 v[72:87], a[184:187], a[252:255], v[72:87]
    v_mfma_f32_32x32x16_bf16 v[88:103], a[180:183], a[248:251], v[88:103]
    s_waitcnt lgkmcnt(6)
    v_mfma_f32_32x32x16_bf16 v[72:87], a[192:195], a[224:227], v[72:87]
    buffer_load_dword v18, v255, s[40:43], s96 offen sc1
    v_mfma_f32_32x32x16_bf16 v[88:103], a[188:191], a[252:255], v[88:103]
    s_waitcnt lgkmcnt(4)
    v_mfma_f32_32x32x16_bf16 v[72:87], a[200:203], a[228:231], v[72:87]
    v_mfma_f32_32x32x16_bf16 v[88:103], a[196:199], a[224:227], v[88:103]
    s_waitcnt lgkmcnt(2)
    v_mfma_f32_32x32x16_bf16 v[72:87], a[208:211], a[232:235], v[72:87]
    v_mfma_f32_32x32x16_bf16 v[88:103], a[204:207], a[228:231], v[88:103]
    s_waitcnt lgkmcnt(0)
    v_mfma_f32_32x32x16_bf16 v[72:87], a[216:219], a[236:239], v[72:87]
    buffer_load_dword v18, v9, s[40:43], s53 offen sc1
    v_mfma_f32_32x32x16_bf16 v[88:103], a[212:215], a[232:235], v[88:103]
    s_nop 9
    v_cvt_pk_bf16_f32 v72, v72, v73
    v_cvt_pk_bf16_f32 v73, v74, v75
    v_mfma_f32_32x32x16_bf16 v[88:103], a[220:223], a[236:239], v[88:103]
    v_cvt_pk_bf16_f32 v74, v76, v77
    v_cvt_pk_bf16_f32 v75, v78, v79
    v_cndmask_b32_e64 v72, v72, v17, s[62:63]
    v_cndmask_b32_e64 v73, v73, v17, s[62:63]
    v_cndmask_b32_e64 v74, v74, v17, s[62:63]
    v_cndmask_b32_e64 v75, v75, v17, s[62:63]
    v_cvt_pk_bf16_f32 v76, v80, v81
    v_cvt_pk_bf16_f32 v77, v82, v83
    v_mfma_f32_32x32x16_bf16 v[200:215], v[136:139], v[72:75], 0
    v_cvt_pk_bf16_f32 v78, v84, v85
    v_cvt_pk_bf16_f32 v79, v86, v87
    v_cndmask_b32_e64 v76, v76, v17, s[62:63]
    v_cndmask_b32_e64 v77, v77, v17, s[62:63]
    v_cndmask_b32_e64 v78, v78, v17, s[62:63]
    v_cndmask_b32_e64 v79, v79, v17, s[62:63]
    v_cvt_pk_bf16_f32 v88, v88, v89
    v_cvt_pk_bf16_f32 v89, v90, v91
    v_mfma_f32_32x32x16_bf16 v[200:215], v[140:143], v[76:79], v[200:215]
    v_cvt_pk_bf16_f32 v90, v92, v93
    v_cvt_pk_bf16_f32 v91, v94, v95
    v_cndmask_b32_e64 v88, v88, v17, s[62:63]
    v_cndmask_b32_e64 v89, v89, v17, s[62:63]
    v_cndmask_b32_e64 v90, v90, v17, s[62:63]
    v_cndmask_b32_e64 v91, v91, v17, s[62:63]
    v_cvt_pk_bf16_f32 v92, v96, v97
    v_cvt_pk_bf16_f32 v93, v98, v99
    v_mfma_f32_32x32x16_bf16 v[200:215], v[168:171], v[88:91], v[200:215]
    v_cvt_pk_bf16_f32 v94, v100, v101
    v_cvt_pk_bf16_f32 v95, v102, v103
    v_cndmask_b32_e64 v92, v92, v17, s[62:63]
    v_cndmask_b32_e64 v93, v93, v17, s[62:63]
    v_cndmask_b32_e64 v94, v94, v17, s[62:63]
    v_cndmask_b32_e64 v95, v95, v17, s[62:63]
    s_nop 1
    v_mfma_f32_32x32x16_bf16 v[200:215], v[172:175], v[92:95], v[200:215]
    buffer_store_dwordx2 v[38:39], v19, s[40:43], s79 offen sc1
    s_nop 10
    ds_write_b128 v10, v[200:203] offset:0
    ds_write_b128 v10, v[204:207] offset:1024
    ds_write_b128 v10, v[208:211] offset:2048
    ds_write_b128 v10, v[212:215] offset:3072
    s_getpc_b64 s[24:25]
L_pcA:
    s_add_u32 s24, s24, L_tabA - L_pcA
    s_addc_u32 s25, s25, 0
    s_waitcnt lgkmcnt(0)
    s_waitcnt vmcnt(9)
    s_barrier
    ds_read_b128 v[80:83], v11 offset:2048
    ds_read_b128 v[84:87], v11 offset:3072
    ds_read_b128 v[88:91], v12 offset:0
    s_mul_i32 s57, s51, 14336
    s_lshl_b32 s86, s83, 8
    ds_read_b128 v[92:95], v12 offset:1024
    s_add_u32 s57, s57, s86
    v_add_u32 v3, 2560, v252
    v_xor_b32_e64 v5, 32, v252
    ds_read_b128 v[96:99], v13 offset:2048
    ds_read_b128 v[100:103], v13 offset:3072
    v_add_u32 v4, 5120, v5
    v_add_u32 v5, 7680, v5
    v_and_b32 v13, 15, v1
    v_lshlrev_b32 v13, 3, v13
    v_lshrrev_b32 v11, 4, v1
    v_lshlrev_b32 v10, 1, v13
    v_lshl_add_u32 v12, v11, 10, v10
    ds_read_b64_tr_b16 a[240:241], v7 offset:0
    ds_read_b64_tr_b16 a[242:243], v7 offset:256
    ds_read_b64_tr_b16 a[244:245], v7 offset:7168
    ds_read_b64_tr_b16 a[246:247], v7 offset:7424
    ds_read_b64_tr_b16 a[248:249], v7 offset:14336
    ds_read_b64_tr_b16 a[250:251], v7 offset:14592
    ds_read_b64_tr_b16 a[252:253], v7 offset:21504
    ds_read_b64_tr_b16 a[254:255], v7 offset:21760
    s_waitcnt lgkmcnt(12)
    v_add_f32 v200, v200, v80
    v_add_f32 v201, v201, v81
    v_add_f32 v202, v202, v82
    v_add_f32 v203, v203, v83
    s_waitcnt lgkmcnt(10)
    v_add_f32 v200, v200, v88
    v_add_f32 v201, v201, v89
    v_add_f32 v206, v206, v86
    v_add_f32 v202, v202, v90
    v_add_f32 v203, v203, v91
    v_add_f32 v204, v204, v84
    v_add_f32 v205, v205, v85
    v_add_f32 v206, v206, v94
    s_waitcnt lgkmcnt(8)
    v_add_f32 v200, v200, v96
    v_add_f32 v201, v201, v97
    v_add_f32 v202, v202, v98
    v_add_f32 v203, v203, v99
    v_cvt_pk_bf16_f32 v200, v200, v201
    v_add_f32 v204, v204, v92
    v_add_f32 v205, v205, v93
    v_add_f32 v206, v206, v102
    v_cvt_pk_bf16_f32 v201, v202, v203
    v_add_f32 v204, v204, v100
    v_add_f32_e64 v205, v205, v101
    v_cvt_pk_bf16_f32 v203, v206, v207
    v_cvt_pk_bf16_f32 v202, v204, v205
    v_bfi_b32 v203, v2, v203, v248
    s_waitcnt lgkmcnt(0)
    v_mfma_f32_32x32x16_bf16 v[40:55], a[240:243], a[0:3], 0
    buffer_store_dwordx4 v[200:203], v16, s[40:43], s4 offen sc1
    ds_read_b64_tr_b16 a[224:225], v7 offset:1024
    ds_read_b64_tr_b16 a[226:227], v7 offset:1280
    ds_read_b64_tr_b16 a[228:229], v7 offset:8192
    v_mfma_f32_32x32x16_bf16 v[40:55], a[244:247], a[8:11], v[40:55]
    ds_read_b64_tr_b16 a[230:231], v7 offset:8448
    ds_read_b64_tr_b16 a[232:233], v7 offset:15360
    ds_read_b64_tr_b16 a[234:235], v7 offset:15616
    ds_read_b64_tr_b16 a[236:237], v7 offset:22528
    ds_read_b64_tr_b16 a[238:239], v7 offset:22784
    v_mfma_f32_32x32x16_bf16 v[40:55], a[248:251], a[16:19], v[40:55]
    s_waitcnt vmcnt(5)
    s_barrier
    s_add_u32 s87, s81, 155648
    s_add_u32 m0, s80, 32768
    v_mfma_f32_32x32x16_bf16 v[40:55], a[252:255], a[24:27], v[40:55]
    buffer_load_dwordx4 v252, s[32:35], s57 offen offset:0  lds
    buffer_load_dwordx4 v3, s[32:35], s57 offen offset:1024  lds
    buffer_load_dwordx4 v4, s[32:35], s57 offen offset:2048  lds
    v_mfma_f32_32x32x16_bf16 v[56:71], a[240:243], a[4:7], 0
    ds_read_b64_tr_b16 a[240:241], v7 offset:2048
    ds_read_b64_tr_b16 a[242:243], v7 offset:2304
    v_lshl_add_u32 v17, v11, 3, v10
    v_add_u32 v10, s87, v17
    v_add_u32 v17, 159744, v17
    v_cndmask_b32_e64 v17, v10, v17, s[60:61]
    s_waitcnt lgkmcnt(8)
    v_mfma_f32_32x32x16_bf16 v[40:55], a[224:227], a[32:35], v[40:55]
    v_sub_u32 v10, v16, v249
    v_add_u32 v10, v10, v12
    v_and_b32 v11, 1, v1
    v_lshlrev_b32 v11, 4, v11
    v_mov_b32 v12, 0x3f80
    v_mfma_f32_32x32x16_bf16 v[56:71], a[244:247], a[12:15], v[56:71]
    ds_read_b64_tr_b16 a[244:245], v7 offset:9216
    ds_read_b64_tr_b16 a[246:247], v7 offset:9472
    v_lshlrev_b32 v12, v11, v12
    v_and_b32 v11, 15, v1
    v_cmp_eq_u32 vcc, 7, v11
    v_lshrrev_b32_e64 v11, 1, v11
    s_waitcnt lgkmcnt(4)
    v_mfma_f32_32x32x16_bf16 v[40:55], a[228:231], a[40:43], v[40:55]
    v_cmp_eq_u32_e64 s[54:55], 0, v11
    v_cmp_eq_u32_e64 s[72:73], 1, v11
    v_cndmask_b32_e64 v12, v12, 0, vcc
    v_cndmask_b32_e64 v28, 0, v12, s[54:55]
    v_cndmask_b32_e64 v29, 0, v12, s[72:73]
    v_mfma_f32_32x32x16_bf16 v[56:71], a[248:251], a[20:23], v[56:71]
    ds_read_b64_tr_b16 a[248:249], v7 offset:16384
    ds_read_b64_tr_b16 a[250:251], v7 offset:16640
    v_cmp_eq_u32_e64 s[54:55], 2, v11
    v_cmp_eq_u32_e64 s[72:73], 3, v11
    s_nop 0
    v_cndmask_b32_e64 v30, 0, v12, s[54:55]
    v_mfma_f32_32x32x16_bf16 v[40:55], a[232:235], a[48:51], v[40:55]
    v_cndmask_b32_e64 v31, 0, v12, s[72:73]
    v_mfma_f32_32x32x16_bf16 v[56:71], a[252:255], a[28:31], v[56:71]
    ds_read_b64_tr_b16 a[252:253], v7 offset:23552
    ds_read_b64_tr_b16 a[254:255], v7 offset:23808
    v_mfma_f32_32x32x16_bf16 v[40:55], a[236:239], a[56:59], v[40:55]
    buffer_load_dwordx4 v5, s[32:35], s57 offen offset:3072  lds
    s_add_u32 m0, s80, 49152
    s_add_u32 s57, s57, 57344
    s_add_u32 s87, s7, 155648
    v_mfma_f32_32x32x16_bf16 v[56:71], a[224:227], a[36:39], v[56:71]
    ds_read_b64_tr_b16 a[224:225], v7 offset:3072
    ds_read_b64_tr_b16 a[226:227], v7 offset:3328
    v_add_u32_e64 v6, s87, v249
    v_xor_b32 v253, 1024, v6
    s_waitcnt lgkmcnt(6)
    v_mfma_f32_32x32x16_bf16 v[40:55], a[240:243], a[64:67], v[40:55]
    buffer_load_dwordx4 v252, s[32:35], s57 offen offset:0  lds
    v_mfma_f32_32x32x16_bf16 v[56:71], a[228:231], a[44:47], v[56:71]
    ds_read_b64_tr_b16 a[228:229], v7 offset:10240
    ds_read_b64_tr_b16 a[230:231], v7 offset:10496
    v_mfma_f32_32x32x16_bf16 v[40:55], a[244:247], a[72:75], v[40:55]
    buffer_load_dwordx4 v3, s[32:35], s57 offen offset:1024  lds
    v_mfma_f32_32x32x16_bf16 v[56:71], a[232:235], a[52:55], v[56:71]
    ds_read_b64_tr_b16 a[232:233], v7 offset:17408
    ds_read_b64_tr_b16 a[234:235], v7 offset:17664
    s_waitcnt lgkmcnt(8)
    v_mfma_f32_32x32x16_bf16 v[40:55], a[248:251], a[80:83], v[40:55]
    v_mfma_f32_32x32x16_bf16 v[56:71], a[236:239], a[60:63], v[56:71]
    ds_read_b64_tr_b16 a[236:237], v7 offset:24576
    ds_read_b64_tr_b16 a[238:239], v7 offset:24832
    s_waitcnt lgkmcnt(8)
    v_mfma_f32_32x32x16_bf16 v[40:55], a[252:255], a[88:91], v[40:55]
    v_mfma_f32_32x32x16_bf16 v[56:71], a[240:243], a[68:71], v[56:71]
    ds_read_b64_tr_b16 a[240:241], v7 offset:4096
    ds_read_b64_tr_b16 a[242:243], v7 offset:4352
    s_waitcnt lgkmcnt(8)
    v_mfma_f32_32x32x16_bf16 v[40:55], a[224:227], a[96:99], v[40:55]
    v_mfma_f32_32x32x16_bf16 v[56:71], a[244:247], a[76:79], v[56:71]
    ds_read_b64_tr_b16 a[244:245], v7 offset:11264
    ds_read_b64_tr_b16 a[246:247], v7 offset:11520
    s_waitcnt lgkmcnt(8)
    v_mfma_f32_32x32x16_bf16 v[40:55], a[228:231], a[104:107], v[40:55]
    v_mfma_f32_32x32x16_bf16 v[56:71], a[248:251], a[84:87], v[56:71]
    buffer_load_dwordx4 v4, s[32:35], s57 offen offset:2048  lds
    ds_read_b64_tr_b16 a[248:249], v7 offset:18432
    ds_read_b64_tr_b16 a[250:251], v7 offset:18688
    s_waitcnt lgkmcnt(8)
    v_mfma_f32_32x32x16_bf16 v[40:55], a[232:235], a[112:115], v[40:55]
    v_mfma_f32_32x32x16_bf16 v[56:71], a[252:255], a[92:95], v[56:71]
    ds_read_b64_tr_b16 a[252:253], v7 offset:25600
    ds_read_b64_tr_b16 a[254:255], v7 offset:25856
    buffer_load_dwordx4 v5, s[32:35], s57 offen offset:3072  lds
    s_waitcnt lgkmcnt(8)
    v_mfma_f32_32x32x16_bf16 v[40:55], a[236:239], a[120:123], v[40:55]
    v_mfma_f32_32x32x16_bf16 v[56:71], a[224:227], a[100:103], v[56:71]
    ds_read_b64_tr_b16 a[224:225], v7 offset:5120
    ds_read_b64_tr_b16 a[226:227], v7 offset:5376
    s_waitcnt lgkmcnt(8)
    v_mfma_f32_32x32x16_bf16 v[40:55], a[240:243], a[128:131], v[40:55]
    v_mfma_f32_32x32x16_bf16 v[56:71], a[228:231], a[108:111], v[56:71]
    ds_read_b64_tr_b16 a[228:229], v7 offset:12288
    ds_read_b64_tr_b16 a[230:231], v7 offset:12544
    s_waitcnt lgkmcnt(8)
    v_mfma_f32_32x32x16_bf16 v[40:55], a[244:247], a[136:139], v[40:55]
    v_mfma_f32_32x32x16_bf16 v[56:71], a[232:235], a[116:119], v[56:71]
    ds_read_b64_tr_b16 a[232:233], v7 offset:19456
    ds_read_b64_tr_b16 a[234:235], v7 offset:19712
    s_waitcnt lgkmcnt(8)
    v_mfma_f32_32x32x16_bf16 v[40:55], a[248:251], a[144:147], v[40:55]
    v_mfma_f32_32x32x16_bf16 v[56:71], a[236:239], a[124:127], v[56:71]
    ds_read_b64_tr_b16 a[236:237], v7 offset:26624
    ds_read_b64_tr_b16 a[238:239], v7 offset:26880
    s_waitcnt lgkmcnt(8)
    v_mfma_f32_32x32x16_bf16 v[40:55], a[252:255], a[152:155], v[40:55]
    v_mfma_f32_32x32x16_bf16 v[56:71], a[240:243], a[132:135], v[56:71]
    ds_read_b64_tr_b16 a[240:241], v7 offset:6144
    ds_read_b64_tr_b16 a[242:243], v7 offset:6400
    s_waitcnt lgkmcnt(8)
    v_mfma_f32_32x32x16_bf16 v[40:55], a[224:227], a[160:163], v[40:55]
    v_mfma_f32_32x32x16_bf16 v[56:71], a[244:247], a[140:143], v[56:71]
    ds_read_b64_tr_b16 a[244:245], v7 offset:13312
    ds_read_b64_tr_b16 a[246:247], v7 offset:13568
    s_waitcnt lgkmcnt(8)
    v_mfma_f32_32x32x16_bf16 v[40:55], a[228:231], a[168:171], v[40:55]
    v_mfma_f32_32x32x16_bf16 v[56:71], a[248:251], a[148:151], v[56:71]
    ds_read_b64_tr_b16 a[248:249], v7 offset:20480
    ds_read_b64_tr_b16 a[250:251], v7 offset:20736
    s_waitcnt lgkmcnt(8)
    v_mfma_f32_32x32x16_bf16 v[40:55], a[232:235], a[176:179], v[40:55]
    v_mfma_f32_32x32x16_bf16 v[56:71], a[252:255], a[156:159], v[56:71]
    ds_read_b64_tr_b16 a[252:253], v7 offset:27648
    ds_read_b64_tr_b16 a[254:255], v7 offset:27904
    s_waitcnt lgkmcnt(8)
    v_mfma_f32_32x32x16_bf16 v[40:55], a[236:239], a[184:187], v[40:55]
    s_waitcnt lgkmcnt(6)
    v_mfma_f32_32x32x16_bf16 v[40:55], a[240:243], a[192:195], v[40:55]
    s_waitcnt lgkmcnt(4)
    v_mfma_f32_32x32x16_bf16 v[40:55], a[244:247], a[200:203], v[40:55]
    s_waitcnt lgkmcnt(2)
    v_mfma_f32_32x32x16_bf16 v[40:55], a[248:251], a[208:211], v[40:55]
    s_waitcnt lgkmcnt(0)
    v_mfma_f32_32x32x16_bf16 v[40:55], a[252:255], a[216:219], v[40:55]
    v_mfma_f32_32x32x16_bf16 v[56:71], a[224:227], a[164:167], v[56:71]
    s_nop 10
    v_cvt_pk_bf16_f32 v40, v40, v41
    v_cvt_pk_bf16_f32 v41, v42, v43
    v_mfma_f32_32x32x16_bf16 v[56:71], a[228:231], a[172:175], v[56:71]
    v_cvt_pk_bf16_f32 v42, v44, v45
    v_cvt_pk_bf16_f32 v43, v46, v47
    v_cvt_pk_bf16_f32 v46, v52, v53
    v_cvt_pk_bf16_f32 v47, v54, v55
    v_cvt_pk_bf16_f32 v44, v48, v49
    v_cvt_pk_bf16_f32 v45, v50, v51
    v_mfma_f32_32x32x16_bf16 v[104:119], v[20:23], v[40:43], 0
    v_cndmask_b32_e64 v46, v46, 0, s[60:61]
    v_cndmask_b32_e64 v47, v47, 0, s[60:61]
    s_nop 1
    v_mfma_f32_32x32x16_bf16 v[104:119], v[24:27], v[44:47], v[104:119]
    v_mfma_f32_32x32x16_bf16 v[56:71], a[232:235], a[180:183], v[56:71]
    s_nop 10
    v_mul_f32 v142, v36, v110
    v_exp_f32_e64 v142, v142 clamp
    v_mfma_f32_32x32x16_bf16 v[56:71], a[236:239], a[188:191], v[56:71]
    v_mul_f32 v150, v36, v118
    v_exp_f32_e64 v150, v150 clamp
    v_max_f32 v110, 0x358637bd, v110
    v_add_f32 v142, v142, v110
    v_max_f32 v118, 0x358637bd, v118
    v_mfma_f32_32x32x16_bf16 v[56:71], a[240:243], a[196:199], v[56:71]
    v_add_f32_e64 v150, v150, v118
    v_cvt_pk_bf16_f32 v143, v150, 0
    v_mfma_f32_32x32x16_bf16 v[56:71], a[244:247], a[204:207], v[56:71]
    v_mfma_f32_32x32x16_bf16 v[56:71], a[248:251], a[212:215], v[56:71]
    v_mfma_f32_32x32x16_bf16 v[56:71], a[252:255], a[220:223], v[56:71]
    v_pk_mul_f32 v[136:137], v[104:105], v[36:37] op_sel_hi:[1,0]
    v_exp_f32_e64 v136, v136 clamp
    s_nop 9
    v_cvt_pk_bf16_f32 v56, v56, v57
    v_cvt_pk_bf16_f32 v57, v58, v59
    v_cvt_pk_bf16_f32 v58, v60, v61
    v_cvt_pk_bf16_f32 v59, v62, v63
    v_cvt_pk_bf16_f32 v62, v68, v69
    v_cvt_pk_bf16_f32 v63, v70, v71
    v_mfma_f32_32x32x16_bf16 v[120:135], v[20:23], v[56:59], 0
    v_cvt_pk_bf16_f32 v60, v64, v65
    v_cvt_pk_bf16_f32 v61, v66, v67
    v_cndmask_b32_e64 v62, v62, 0, s[60:61]
    v_cndmask_b32_e64 v63, v63, 0, s[60:61]
    v_exp_f32_e64 v137, v137 clamp
    s_nop 0
    v_mfma_f32_32x32x16_bf16 v[120:135], v[24:27], v[60:63], v[120:135]
    v_max_f32 v104, 0x358637bd, v104
    v_max_f32 v105, 0x358637bd, v105
    buffer_load_dwordx2 v[38:39], v13, s[40:43], s8 offen sc1
    buffer_load_dwordx4 v[200:203], v10, s[40:43], s5 offen offset:0 sc1
    buffer_load_dwordx4 v[204:207], v10, s[40:43], s5 offen offset:256 sc1
    buffer_load_dwordx4 v[208:211], v10, s[40:43], s5 offen offset:512 sc1
    buffer_load_dwordx4 v[212:215], v10, s[40:43], s5 offen offset:768 sc1
    s_nop 4
    v_pk_mul_f32 v[168:169], v[120:121], v[36:37] op_sel_hi:[1,0]
    v_pk_mul_f32 v[138:139], v[106:107], v[36:37] op_sel_hi:[1,0]
    v_exp_f32_e64 v168, v168 clamp
    v_exp_f32_e64 v169, v169 clamp
    v_pk_mul_f32 v[170:171], v[122:123], v[36:37] op_sel_hi:[1,0]
    v_exp_f32_e64 v138, v138 clamp
    buffer_load_dwordx4 v[216:219], v10, s[40:43], s6 offen offset:0 sc1
    v_exp_f32_e64 v139, v139 clamp
    v_pk_mul_f32 v[140:141], v[108:109], v[36:37] op_sel_hi:[1,0]
    v_exp_f32_e64 v170, v170 clamp
    v_exp_f32_e64 v171, v171 clamp
    v_pk_mul_f32 v[172:173], v[124:125], v[36:37] op_sel_hi:[1,0]
    v_mul_f32 v174, v36, v126
    v_exp_f32_e64 v140, v140 clamp
    v_exp_f32_e64 v141, v141 clamp
    buffer_load_dwordx4 v[220:223], v10, s[40:43], s6 offen offset:256 sc1
    v_pk_mul_f32 v[144:145], v[112:113], v[36:37] op_sel_hi:[1,0]
    v_pk_mul_f32 v[146:147], v[114:115], v[36:37] op_sel_hi:[1,0]
    v_pk_mul_f32 v[148:149], v[116:117], v[36:37] op_sel_hi:[1,0]
    v_max_f32 v120, 0x358637bd, v120
    v_max_f32 v121, 0x358637bd, v121
    v_exp_f32_e64 v172, v172 clamp
    v_exp_f32_e64 v173, v173 clamp
    v_exp_f32_e64 v174, v174 clamp
    v_pk_mul_f32 v[176:177], v[128:129], v[36:37] op_sel_hi:[1,0]
    v_pk_mul_f32 v[178:179], v[130:131], v[36:37] op_sel_hi:[1,0]
    buffer_load_dwordx4 v[224:227], v10, s[40:43], s6 offen offset:512 sc1
    v_pk_mul_f32 v[180:181], v[132:133], v[36:37] op_sel_hi:[1,0]
    v_mul_f32_e64 v182, v36, v134
    v_pk_add_f32 v[136:137], v[136:137], v[104:105]
    v_max_f32 v106, 0x358637bd, v106
    v_max_f32 v107, 0x358637bd, v107
    v_exp_f32_e64 v144, v144 clamp
    v_exp_f32_e64 v145, v145 clamp
    v_exp_f32_e64 v146, v146 clamp
    v_exp_f32_e64 v147, v147 clamp
    v_exp_f32_e64 v148, v148 clamp
    buffer_load_dwordx4 v[228:231], v10, s[40:43], s6 offen offset:768 sc1
    v_exp_f32_e64 v149, v149 clamp
    v_pk_add_f32 v[168:169], v[168:169], v[120:121]
    v_max_f32 v122, 0x358637bd, v122
    v_max_f32 v123, 0x358637bd, v123
    v_exp_f32_e64 v176, v176 clamp
    v_exp_f32_e64 v177, v177 clamp
    v_exp_f32_e64 v178, v178 clamp
    v_exp_f32_e64 v179, v179 clamp
    v_exp_f32_e64 v180, v180 clamp
    v_exp_f32_e64 v181, v181 clamp
    v_exp_f32_e64 v182, v182 clamp
    v_cvt_pk_bf16_f32 v136, v136, v137
    v_pk_add_f32 v[138:139], v[138:139], v[106:107]
    v_max_f32 v108, 0x358637bd, v108
    v_max_f32 v109, 0x358637bd, v109
    v_cvt_pk_bf16_f32 v168, v168, v169
    v_pk_add_f32 v[170:171], v[170:171], v[122:123]
    v_max_f32 v124, 0x358637bd, v124
    v_max_f32 v125, 0x358637bd, v125
    v_max_f32 v126, 0x358637bd, v126
    v_cvt_pk_bf16_f32 v137, v138, v139
    v_pk_add_f32 v[140:141], v[140:141], v[108:109]
    v_max_f32 v112, 0x358637bd, v112
    v_max_f32 v113, 0x358637bd, v113
    v_max_f32 v114, 0x358637bd, v114
    v_max_f32 v115, 0x358637bd, v115
    v_max_f32 v116, 0x358637bd, v116
    v_max_f32 v117, 0x358637bd, v117
    v_cvt_pk_bf16_f32 v169, v170, v171
    v_pk_add_f32 v[172:173], v[172:173], v[124:125]
    v_add_f32_e64 v174, v174, v126
    v_max_f32 v128, 0x358637bd, v128
    v_max_f32 v129, 0x358637bd, v129
    v_max_f32 v130, 0x358637bd, v130
    v_max_f32 v131, 0x358637bd, v131
    v_max_f32 v132, 0x358637bd, v132
    v_max_f32 v133, 0x358637bd, v133
    v_max_f32 v134, 0x358637bd, v134
    v_cvt_pk_bf16_f32 v138, v140, v141
    v_cvt_pk_bf16_f32 v139, v142, 0
    v_pk_add_f32 v[144:145], v[144:145], v[112:113]
    v_pk_add_f32 v[146:147], v[146:147], v[114:115]
    v_pk_add_f32 v[148:149], v[148:149], v[116:117]
    v_cvt_pk_bf16_f32 v170, v172, v173
    v_cvt_pk_bf16_f32 v171, v174, 0
    v_pk_add_f32 v[176:177], v[176:177], v[128:129]
    v_pk_add_f32 v[178:179], v[178:179], v[130:131]
    v_pk_add_f32 v[180:181], v[180:181], v[132:133]
    v_add_f32_e64 v182, v182, v134
    v_cvt_pk_bf16_f32 v140, v144, v145
    v_cvt_pk_bf16_f32 v141, v146, v147
    v_cvt_pk_bf16_f32 v142, v148, v149
    v_cvt_pk_bf16_f32 v172, v176, v177
    v_cvt_pk_bf16_f32 v173, v178, v179
    v_cvt_pk_bf16_f32 v174, v180, v181
    v_cvt_pk_bf16_f32 v175, v182, 0
    s_waitcnt vmcnt(0)
L_part_chkA:
    v_mfma_f32_16x16x32_bf16 v[72:75], v[28:31], v[200:203], 0
    v_max3_u32 v232, v203, v207, v211
    v_min3_u32 v244, v203, v207, v211
    v_mfma_f32_16x16x32_bf16 v[76:79], v[28:31], v[204:207], 0
    v_max3_u32 v232, v232, v215, v219
    v_min3_u32 v244, v244, v215, v219
    v_mfma_f32_16x16x32_bf16 v[80:83], v[28:31], v[208:211], 0
    v_max3_u32 v232, v232, v223, v227
    v_min3_u32 v244, v244, v223, v227
    v_mfma_f32_16x16x32_bf16 v[84:87], v[28:31], v[212:215], 0
    v_max_u32 v232, v232, v231
    v_min_u32 v244, v244, v231
    v_mfma_f32_16x16x32_bf16 v[72:75], v[28:31], v[216:219], v[72:75]
    v_xor_b32 v232, v232, v248
    v_xor_b32 v244, v244, v248
    v_mfma_f32_16x16x32_bf16 v[76:79], v[28:31], v[220:223], v[76:79]
    v_xor_b32 v233, s99, v39
    v_or_b32 v232, v232, v244
    v_mfma_f32_16x16x32_bf16 v[80:83], v[28:31], v[224:227], v[80:83]
    v_cmp_ne_u32_e64 s[72:73], 0, v233
    v_lshrrev_b32 v232, 16, v232
    v_mfma_f32_16x16x32_bf16 v[84:87], v[28:31], v[228:231], v[84:87]
    v_xor_b32 v244, s58, v38
    v_lshrrev_b32 v233, 4, v233
    v_or3_b32 v232, v232, v244, v233
    v_cmp_ne_u32 vcc, 0, v232
    s_nop 1
    s_cbranch_vccnz L_part_retryA
    v_and_b32 v8, 0x300, v249
    v_lshrrev_b32 v8, 2, v8
    global_load_dwordx4 v[20:23], v8, s[24:25] offset:0
    global_load_dwordx4 v[24:27], v8, s[24:25] offset:16
    global_load_dwordx4 v[32:35], v8, s[24:25] offset:32
    global_load_dwordx2 v[254:255], v8, s[24:25] offset:48
    v_cvt_pk_bf16_f32 v72, v72, v73
    v_cvt_pk_bf16_f32 v73, v74, v75
    v_cvt_pk_bf16_f32 v76, v76, v77
    v_cvt_pk_bf16_f32 v77, v78, v79
    v_cvt_pk_bf16_f32 v80, v80, v81
    v_cvt_pk_bf16_f32 v81, v82, v83
    v_cvt_pk_bf16_f32 v84, v84, v85
    v_cvt_pk_bf16_f32 v85, v86, v87
    ds_write_b64 v17, v[72:73] offset:0
    ds_write_b64 v17, v[76:77] offset:256
    ds_write_b64 v17, v[80:81] offset:512
    ds_write_b64 v17, v[84:85] offset:768
    s_waitcnt lgkmcnt(0)
    s_barrier
    ds_read_b128 v[88:91], v6
    ds_read_b128 v[92:95], v253
    s_add_u32 m0, s80, 65536
    s_add_u32 s57, s57, 57344
    v_xor_b32_e64 v251, 32, v250
    buffer_load_dwordx4 v252, s[32:35], s57 offen offset:0  lds
    buffer_load_dwordx4 v3, s[32:35], s57 offen offset:1024  lds
    buffer_load_dwordx4 v4, s[32:35], s57 offen offset:2048  lds
    buffer_load_dwordx4 v5, s[32:35], s57 offen offset:3072  lds
    s_add_u32 m0, s80, 81920
    s_add_u32 s57, s57, 57344
    v_mov_b32 v38, s58
    v_mov_b32 v39, s59
    v_add_u32 v14, 0x10000, v250
    buffer_load_dwordx4 v252, s[32:35], s57 offen offset:0  lds
    v_add_u32 v15, 0x10000, v251
    ds_read_b64_tr_b16 a[0:1], v250 offset:0
    ds_read_b64_tr_b16 a[2:3], v250 offset:1024
    ds_read_b64_tr_b16 a[4:5], v251 offset:0
    ds_read_b64_tr_b16 a[6:7], v251 offset:1024
    ds_read_b64_tr_b16 a[8:9], v250 offset:8192
    ds_read_b64_tr_b16 a[10:11], v250 offset:9216
    s_waitcnt lgkmcnt(7)
    v_mfma_f32_32x32x16_bf16 v[104:119], v[88:91], v[136:139], 0
    ds_read_b64_tr_b16 a[12:13], v251 offset:8192
    ds_read_b64_tr_b16 a[14:15], v251 offset:9216
    buffer_load_dwordx4 v3, s[32:35], s57 offen offset:1024  lds
    ds_read_b64_tr_b16 a[16:17], v250 offset:16384
    v_mfma_f32_32x32x16_bf16 v[120:135], v[88:91], v[168:171], 0
    ds_read_b64_tr_b16 a[18:19], v250 offset:17408
    ds_read_b64_tr_b16 a[20:21], v251 offset:16384
    ds_read_b64_tr_b16 a[22:23], v251 offset:17408
    ds_read_b64_tr_b16 a[24:25], v250 offset:24576
    ds_read_b64_tr_b16 a[26:27], v250 offset:25600
    s_waitcnt lgkmcnt(14)
    v_mfma_f32_32x32x16_bf16 v[104:119], v[92:95], v[140:143], v[104:119]
    ds_read_b64_tr_b16 a[28:29], v251 offset:24576
    ds_read_b64_tr_b16 a[30:31], v251 offset:25600
    buffer_load_dwordx4 v4, s[32:35], s57 offen offset:2048  lds
    v_mfma_f32_32x32x16_bf16 v[120:135], v[92:95], v[172:175], v[120:135]
    s_nop 7
    v_mov_b32 v236, v116
    s_nop 1
    v_permlane32_swap_b32 v116, v236
    v_add_f32 v236, 0x358637bd, v236
    v_rcp_f32 v236, v236
    v_mov_b32 v240, v132
    v_mul_f32 v104, v104, v236
    buffer_load_dwordx4 v5, s[32:35], s57 offen offset:3072  lds
    s_add_u32 m0, s80, 98304
    s_add_u32 s57, s57, 57344
    v_permlane32_swap_b32 v132, v240
    v_add_f32 v240, 0x358637bd, v240
    v_rcp_f32 v240, v240
    v_mul_f32 v105, v105, v236
    v_pk_mul_f32 v[120:121], v[120:121], v[240:241] op_sel_hi:[1,0]
    s_lshl_b32 s56, s50, 3
    v_cvt_pk_bf16_f32 v104, v104, v105
    v_mul_f32 v106, v106, v236
    v_mul_f32 v107, v107, v236
    v_cvt_pk_bf16_f32 v120, v120, v121
    buffer_load_dwordx4 v252, s[32:35], s57 offen offset:0  lds
    v_pk_mul_f32 v[122:123], v[122:123], v[240:241] op_sel_hi:[1,0]
    s_add_u32 s88, s53, s56
    v_cvt_pk_bf16_f32 v105, v106, v107
    v_mul_f32 v108, v108, v236
    v_mul_f32 v109, v109, v236
    v_mul_f32 v110, v110, v236
    v_mul_f32 v111, v111, v236
    v_cvt_pk_bf16_f32 v121, v122, v123
    v_pk_mul_f32 v[124:125], v[124:125], v[240:241] op_sel_hi:[1,0]
    v_pk_mul_f32 v[126:127], v[126:127], v[240:241] op_sel_hi:[1,0]
    s_xor_b32 s96, s90, 32768
    v_cvt_pk_bf16_f32 v106, v108, v109
    v_cvt_pk_bf16_f32 v107, v110, v111
    buffer_load_dwordx4 v3, s[32:35], s57 offen offset:1024  lds
    v_mul_f32 v112, v112, v236
    v_mul_f32 v113, v113, v236
    v_mul_f32 v114, v114, v236
    v_mul_f32 v115, v115, v236
    v_mul_f32 v116, v116, v236
    v_mul_f32 v117, v117, v236
    v_mul_f32 v118, v118, v236
    v_mul_f32 v119, v119, v236
    v_cvt_pk_bf16_f32 v122, v124, v125
    v_cvt_pk_bf16_f32 v123, v126, v127
    v_pk_mul_f32 v[128:129], v[128:129], v[240:241] op_sel_hi:[1,0]
    v_pk_mul_f32 v[130:131], v[130:131], v[240:241] op_sel_hi:[1,0]
    v_pk_mul_f32 v[132:133], v[132:133], v[240:241] op_sel_hi:[1,0]
    v_pk_mul_f32 v[134:135], v[134:135], v[240:241] op_sel_hi:[1,0]
    buffer_load_dwordx4 v4, s[32:35], s57 offen offset:2048  lds
    s_add_u32 s86, s90, 16384
    v_cvt_pk_bf16_f32 v108, v112, v113
    v_cvt_pk_bf16_f32 v109, v114, v115
    v_cvt_pk_bf16_f32 v110, v116, v117
    v_cvt_pk_bf16_f32 v111, v118, v119
    v_cvt_pk_bf16_f32 v124, v128, v129
    v_cvt_pk_bf16_f32 v125, v130, v131
    v_cvt_pk_bf16_f32 v126, v132, v133
    v_cvt_pk_bf16_f32 v127, v134, v135
    s_add_u32 s87, s96, 16384
    buffer_load_dwordx4 v5, s[32:35], s57 offen offset:3072  lds
    s_cmp_lg_u64 s[72:73], 0
    s_cbranch_scc1 L_farA
L_pubA:
    s_add_u32 m0, s80, 114688
    s_add_u32 s57, s57, 57344
    s_lshl_b32 s56, s49, 2
    s_add_u32 s56, s56, s84
    s_mul_i32 s89, s56, 114688
    s_mul_i32 s56, s48, 896
    s_add_u32 s89, s89, s56
    s_lshl_b32 s56, s83, 2
    s_add_u32 s56, s56, s51
    s_cmp_ge_u32 s56, 14
    v_and_b32 v242, 15, v1
    v_lshlrev_b32 v235, 4, v242
    v_bfe_u32 v243, v1, 4, 1
    v_lshrrev_b32 v244, 5, v1
    s_waitcnt vmcnt(15)
    v_add_u32 v20, v20, v235
    v_add_u32 v21, v21, v235
    buffer_store_dwordx4 v[104:107], v249, s[40:43], s90 offen
    v_add_u32 v22, v22, v235
    v_add_u32 v23, v23, v235
    s_waitcnt vmcnt(15)
    v_add_u32 v24, v24, v235
    v_add_u32 v25, v25, v235
    v_add_u32 v26, v26, v235
    v_add_u32 v27, v27, v235
    s_waitcnt vmcnt(14)
    v_add_u32 v32, v32, v235
    v_add_u32 v33, v33, v235
    v_add_u32 v34, v34, v235
    v_add_u32 v35, v35, v235
    s_waitcnt vmcnt(13)
    v_add_u32 v254, v254, v235
    v_add_u32 v255, v255, v235
    buffer_store_dwordx4 v[108:111], v249, s[40:43], s86 offen
    s_cselect_b32 s86, 0x40000000, 0
    s_lshl_b32 s56, s56, 6
    s_add_u32 s64, s89, s56
    s_add_u32 s65, s64, 28672
    s_add_u32 s66, s64, 57344
    s_add_u32 s67, s64, 86016
    buffer_store_dwordx4 v[120:123], v249, s[40:43], s96 offen
    buffer_store_dwordx4 v[124:127], v249, s[40:43], s87 offen
    s_lshl_b32 s87, s51, 12
    s_add_u32 s87, s87, 65536
    v_lshl_add_u32 v242, v242, 6, s87
    v_lshl_add_u32 v242, v243, 3, v242
    v_bfe_u32 v243, v1, 1, 2
    v_xor_b32 v243, v243, v244
    v_lshl_add_u32 v236, v243, 4, v242
    v_bfe_u32 v243, v1, 3, 2
    v_xor_b32 v243, v243, v1
    v_lshrrev_b32 v242, 2, v1
    v_and_b32_e64 v243, 3, v243
    v_lshl_add_u32 v244, v242, 6, s87
    v_lshl_add_u32 v240, v243, 4, v244
    s_and_b32 s56, s85, 127
    v_mul_u32_u24 v242, 1792, v242
    v_and_b32 v243, 3, v1
    buffer_load_dwordx4 v252, s[32:35], s57 offen offset:0  lds
    s_or_b32 s56, s56, s51
    v_lshl_add_u32 v242, v243, 4, v242
    s_cmp_eq_u32 s56, 0
    v_add_u32 v241, s86, v242
    s_cselect_b32 s56, 0, 0x20000000
    s_lshl_b32 s86, s48, 7
    s_or_b32 s56, s56, s86
    v_add_u32 v234, s56, v19
    s_lshl2_add_u32 s56, s52, s84
    s_lshl2_add_u32 s56, s56, s51
    s_lshl_b32 s56, s56, 14
    s_add_u32 s89, s56, 2097152
    v_and_b32 v242, 15, v1
    s_lshl_b32 s91, s51, 14
    buffer_load_dwordx4 v3, s[32:35], s57 offen offset:1024  lds
    v_xor_b32 v237, 32, v236
    v_cmp_eq_u32_e64 s[74:75], s50, v242
    buffer_load_dwordx4 v4, s[32:35], s57 offen offset:2048  lds
    buffer_load_dwordx4 v5, s[32:35], s57 offen offset:3072  lds
    s_mov_b32 m0, s91
    s_waitcnt vmcnt(4)
    buffer_store_dwordx2 v[38:39], v19, s[40:43], s88 offen
L_joinA:
    buffer_load_dwordx2 v[232:233], v13, s[40:43], s97 offen sc1
    s_waitcnt lgkmcnt(0)
    s_barrier
    ds_read_b64_tr_b16 a[32:33], v250 offset:32768
    ds_read_b64_tr_b16 a[34:35], v250 offset:33792
    ds_read_b64_tr_b16 a[36:37], v251 offset:32768
    ds_read_b64_tr_b16 a[38:39], v251 offset:33792
    ds_read_b64_tr_b16 a[40:41], v250 offset:40960
    ds_read_b64_tr_b16 a[42:43], v250 offset:41984
    ds_read_b64_tr_b16 a[44:45], v251 offset:40960
    ds_read_b64_tr_b16 a[46:47], v251 offset:41984
    ds_read_b64_tr_b16 a[48:49], v250 offset:49152
    ds_read_b64_tr_b16 a[50:51], v250 offset:50176
    ds_read_b64_tr_b16 a[52:53], v251 offset:49152
    ds_read_b64_tr_b16 a[54:55], v251 offset:50176
    ds_read_b64_tr_b16 a[56:57], v250 offset:57344
    ds_read_b64_tr_b16 a[58:59], v250 offset:58368
    ds_read_b64_tr_b16 a[60:61], v251 offset:57344
    ds_read_b64_tr_b16 a[62:63], v251 offset:58368
    ds_read_b64_tr_b16 a[64:65], v14 offset:0
    ds_read_b64_tr_b16 a[66:67], v14 offset:1024
    ds_read_b64_tr_b16 a[68:69], v15 offset:0
    ds_read_b64_tr_b16 a[70:71], v15 offset:1024
    ds_read_b64_tr_b16 a[72:73], v14 offset:8192
    ds_read_b64_tr_b16 a[74:75], v14 offset:9216
    ds_read_b64_tr_b16 a[76:77], v15 offset:8192
    ds_read_b64_tr_b16 a[78:79], v15 offset:9216
L_pollA:
    s_waitcnt vmcnt(0)
    v_xor_b32 v232, s58, v232
    v_xor_b32 v233, s59, v233
    v_or_b32_e64 v232, v232, v233
    v_cmp_ne_u32 vcc, 0, v232
    s_nop 1
    s_andn2_b64 vcc, vcc, s[74:75]
    s_cbranch_vccnz L_repollA
L_seenA:
    buffer_load_dwordx4 v249, s[40:43], s89 offen offset:0 sc1 lds
    buffer_load_dwordx4 v249, s[40:43], s89 offen offset:1024 sc1 lds
    buffer_load_dwordx4 v249, s[40:43], s89 offen offset:2048 sc1 lds
    buffer_load_dwordx4 v249, s[40:43], s89 offen offset:3072 sc1 lds
    s_add_u32 m0, s91, 4096
    s_add_u32 s89, s89, 4096
    buffer_load_dwordx4 v249, s[40:43], s89 offen offset:0 sc1 lds
    buffer_load_dwordx4 v249, s[40:43], s89 offen offset:1024 sc1 lds
    buffer_load_dwordx4 v249, s[40:43], s89 offen offset:2048 sc1 lds
    buffer_load_dwordx4 v249, s[40:43], s89 offen offset:3072 sc1 lds
    s_waitcnt vmcnt(4)
    s_barrier
    ds_read_b64 v[136:137], v20 offset:0
    ds_read_b64 v[138:139], v21 offset:0
    ds_read_b64 v[140:141], v20 offset:256
    ds_read_b64 v[142:143], v21 offset:256
    ds_read_b64 v[144:145], v20 offset:32768
    ds_read_b64 v[146:147], v21 offset:32768
    ds_read_b64 v[148:149], v20 offset:33024
    ds_read_b64 v[150:151], v21 offset:33024
    s_waitcnt lgkmcnt(6)
    v_mfma_f32_16x16x32_bf16 v[40:43], a[0:3], v[136:139], 0
    ds_read_b64 v[152:153], v22 offset:0
    ds_read_b64 v[154:155], v23 offset:0
    v_mfma_f32_16x16x32_bf16 v[44:47], a[4:7], v[136:139], 0
    ds_read_b64 v[156:157], v22 offset:256
    ds_read_b64 v[158:159], v23 offset:256
    s_waitcnt lgkmcnt(8)
    v_mfma_f32_16x16x32_bf16 v[48:51], a[0:3], v[140:143], 0
    ds_read_b64 v[160:161], v22 offset:32768
    ds_read_b64 v[162:163], v23 offset:32768
    v_mfma_f32_16x16x32_bf16 v[52:55], a[4:7], v[140:143], 0
    ds_read_b64 v[164:165], v22 offset:33024
    ds_read_b64 v[166:167], v23 offset:33024
    s_waitcnt lgkmcnt(10)
    v_mfma_f32_16x16x32_bf16 v[56:59], a[0:3], v[144:147], 0
    ds_read_b64 v[168:169], v24 offset:0
    ds_read_b64 v[170:171], v25 offset:0
    v_mfma_f32_16x16x32_bf16 v[60:63], a[4:7], v[144:147], 0
    ds_read_b64 v[172:173], v24 offset:256
    ds_read_b64 v[174:175], v25 offset:256
    s_waitcnt lgkmcnt(12)
    v_mfma_f32_16x16x32_bf16 v[64:67], a[0:3], v[148:151], 0
    ds_read_b64 v[176:177], v24 offset:32768
    ds_read_b64 v[178:179], v25 offset:32768
    v_mfma_f32_16x16x32_bf16 v[68:71], a[4:7], v[148:151], 0
    ds_read_b64 v[180:181], v24 offset:33024
    ds_read_b64 v[182:183], v25 offset:33024
    s_waitcnt vmcnt(2)
    s_barrier
    s_waitcnt lgkmcnt(13)
    v_mfma_f32_16x16x32_bf16 v[40:43], a[8:11], v[152:155], v[40:43]
    s_add_u32 m0, s91, 8192
    s_add_u32 s89, s89, 4096
    buffer_load_dwordx4 v249, s[40:43], s89 offen offset:0 sc1 lds
    ds_read_b64 v[136:137], v26 offset:0
    v_mfma_f32_16x16x32_bf16 v[44:47], a[12:15], v[152:155], v[44:47]
    ds_read_b64 v[138:139], v27 offset:0
    s_waitcnt lgkmcnt(10)
    v_mfma_f32_16x16x32_bf16 v[48:51], a[8:11], v[156:159], v[48:51]
    buffer_load_dwordx4 v249, s[40:43], s89 offen offset:1024 sc1 lds
    ds_read_b64 v[140:141], v26 offset:256
    v_mfma_f32_16x16x32_bf16 v[52:55], a[12:15], v[156:159], v[52:55]
    ds_read_b64 v[142:143], v27 offset:256
    v_mfma_f32_16x16x32_bf16 v[56:59], a[8:11], v[160:163], v[56:59]
    buffer_load_dwordx4 v249, s[40:43], s89 offen offset:2048 sc1 lds
    ds_read_b64 v[144:145], v26 offset:32768
    v_mfma_f32_16x16x32_bf16 v[60:63], a[12:15], v[160:163], v[60:63]
    ds_read_b64 v[146:147], v27 offset:32768
    v_mfma_f32_16x16x32_bf16 v[64:67], a[8:11], v[164:167], v[64:67]
    buffer_load_dwordx4 v249, s[40:43], s89 offen offset:3072 sc1 lds
    ds_read_b64 v[148:149], v26 offset:33024
    v_mfma_f32_16x16x32_bf16 v[68:71], a[12:15], v[164:167], v[68:71]
    ds_read_b64 v[150:151], v27 offset:33024
    s_waitcnt lgkmcnt(8)
    v_mfma_f32_16x16x32_bf16 v[40:43], a[16:19], v[168:171], v[40:43]
    s_add_u32 m0, s91, 12288
    s_add_u32 s89, s89, 4096
    buffer_load_dwordx4 v249, s[40:43], s89 offen offset:0 sc1 lds
    ds_read_b64 v[152:153], v32 offset:0
    v_mfma_f32_16x16x32_bf16 v[44:47], a[20:23], v[168:171], v[44:47]
    ds_read_b64 v[154:155], v33 offset:0
    v_mfma_f32_16x16x32_bf16 v[48:51], a[16:19], v[172:175], v[48:51]
    buffer_load_dwordx4 v249, s[40:43], s89 offen offset:1024 sc1 lds
    ds_read_b64 v[156:157], v32 offset:256
    v_mfma_f32_16x16x32_bf16 v[52:55], a[20:23], v[172:175], v[52:55]
    ds_read_b64 v[158:159], v33 offset:256
    v_mfma_f32_16x16x32_bf16 v[56:59], a[16:19], v[176:179], v[56:59]
    buffer_load_dwordx4 v249, s[40:43], s89 offen offset:2048 sc1 lds
    ds_read_b64 v[160:161], v32 offset:32768
    v_mfma_f32_16x16x32_bf16 v[60:63], a[20:23], v[176:179], v[60:63]
    ds_read_b64 v[162:163], v33 offset:32768
    v_mfma_f32_16x16x32_bf16 v[64:67], a[16:19], v[180:183], v[64:67]
    buffer_load_dwordx4 v249, s[40:43], s89 offen offset:3072 sc1 lds
    ds_read_b64 v[164:165], v32 offset:33024
    v_mfma_f32_16x16x32_bf16 v[68:71], a[20:23], v[180:183], v[68:71]
    ds_read_b64 v[166:167], v33 offset:33024
    s_waitcnt vmcnt(8)
    s_barrier
    s_waitcnt lgkmcnt(8)
    v_mfma_f32_16x16x32_bf16 v[40:43], a[24:27], v[136:139], v[40:43]
    s_add_u32 m0, s80, 131072
    s_add_u32 s57, s57, 57344
    buffer_load_dwordx4 v252, s[32:35], s57 offen offset:0  lds
    ds_read_b64 v[168:169], v34 offset:0
    ds_read_b64 v[170:171], v35 offset:0
    v_mfma_f32_16x16x32_bf16 v[44:47], a[28:31], v[136:139], v[44:47]
    ds_read_b64_tr_b16 a[80:81], v14 offset:16384
    ds_read_b64 v[172:173], v34 offset:256
    v_mfma_f32_16x16x32_bf16 v[48:51], a[24:27], v[140:143], v[48:51]
    buffer_load_dwordx4 v3, s[32:35], s57 offen offset:1024  lds
    ds_read_b64 v[174:175], v35 offset:256
    ds_read_b64_tr_b16 a[82:83], v14 offset:17408
    v_mfma_f32_16x16x32_bf16 v[52:55], a[28:31], v[140:143], v[52:55]
    ds_read_b64 v[176:177], v34 offset:32768
    ds_read_b64 v[178:179], v35 offset:32768
    v_mfma_f32_16x16x32_bf16 v[56:59], a[24:27], v[144:147], v[56:59]
    buffer_load_dwordx4 v4, s[32:35], s57 offen offset:2048  lds
    ds_read_b64_tr_b16 a[84:85], v15 offset:16384
    ds_read_b64 v[180:181], v34 offset:33024
    v_mfma_f32_16x16x32_bf16 v[60:63], a[28:31], v[144:147], v[60:63]
    ds_read_b64 v[182:183], v35 offset:33024
    ds_read_b64_tr_b16 a[86:87], v15 offset:17408
    v_mfma_f32_16x16x32_bf16 v[64:67], a[24:27], v[148:151], v[64:67]
    buffer_load_dwordx4 v5, s[32:35], s57 offen offset:3072  lds
    v_mfma_f32_16x16x32_bf16 v[68:71], a[28:31], v[148:151], v[68:71]
    s_waitcnt lgkmcnt(12)
    v_mfma_f32_16x16x32_bf16 v[40:43], a[32:35], v[152:155], v[40:43]
    buffer_store_dwordx2 v[38:39], v234, s[40:43], 0 offen sc1
    ds_read_b64 v[136:137], v254 offset:0
    ds_read_b64 v[138:139], v255 offset:0
    v_mfma_f32_16x16x32_bf16 v[44:47], a[36:39], v[152:155], v[44:47]
    ds_read_b64_tr_b16 a[88:89], v14 offset:24576
    ds_read_b64 v[140:141], v254 offset:256
    v_mfma_f32_16x16x32_bf16 v[48:51], a[32:35], v[156:159], v[48:51]
    ds_read_b64 v[142:143], v255 offset:256
    ds_read_b64_tr_b16 a[90:91], v14 offset:25600
    v_mfma_f32_16x16x32_bf16 v[52:55], a[36:39], v[156:159], v[52:55]
    ds_read_b64 v[144:145], v254 offset:32768
    ds_read_b64 v[146:147], v255 offset:32768
    v_mfma_f32_16x16x32_bf16 v[56:59], a[32:35], v[160:163], v[56:59]
    ds_read_b64_tr_b16 a[92:93], v15 offset:24576
    ds_read_b64 v[148:149], v254 offset:33024
    v_mfma_f32_16x16x32_bf16 v[60:63], a[36:39], v[160:163], v[60:63]
    ds_read_b64 v[150:151], v255 offset:33024
    ds_read_b64_tr_b16 a[94:95], v15 offset:25600
    v_mfma_f32_16x16x32_bf16 v[64:67], a[32:35], v[164:167], v[64:67]
    v_mfma_f32_16x16x32_bf16 v[68:71], a[36:39], v[164:167], v[68:71]
    s_waitcnt vmcnt(9)
    s_barrier
    s_waitcnt lgkmcnt(12)
    v_mfma_f32_16x16x32_bf16 v[40:43], a[40:43], v[168:171], v[40:43]
    ds_read_b64 v[152:153], v20 offset:8192
    v_mfma_f32_16x16x32_bf16 v[44:47], a[44:47], v[168:171], v[44:47]
    ds_read_b64 v[154:155], v21 offset:8192
    v_mfma_f32_16x16x32_bf16 v[48:51], a[40:43], v[172:175], v[48:51]
    ds_read_b64 v[156:157], v20 offset:8448
    v_mfma_f32_16x16x32_bf16 v[52:55], a[44:47], v[172:175], v[52:55]
    ds_read_b64 v[158:159], v21 offset:8448
    v_mfma_f32_16x16x32_bf16 v[56:59], a[40:43], v[176:179], v[56:59]
    ds_read_b64 v[160:161], v20 offset:40960
    v_mfma_f32_16x16x32_bf16 v[60:63], a[44:47], v[176:179], v[60:63]
    ds_read_b64 v[162:163], v21 offset:40960
    v_mfma_f32_16x16x32_bf16 v[64:67], a[40:43], v[180:183], v[64:67]
    ds_read_b64 v[164:165], v20 offset:41216
    v_mfma_f32_16x16x32_bf16 v[68:71], a[44:47], v[180:183], v[68:71]
    ds_read_b64 v[166:167], v21 offset:41216
    s_waitcnt lgkmcnt(10)
    v_mfma_f32_16x16x32_bf16 v[40:43], a[48:51], v[136:139], v[40:43]
    ds_read_b64 v[168:169], v22 offset:8192
    v_mfma_f32_16x16x32_bf16 v[44:47], a[52:55], v[136:139], v[44:47]
    ds_read_b64 v[170:171], v23 offset:8192
    v_mfma_f32_16x16x32_bf16 v[48:51], a[48:51], v[140:143], v[48:51]
    ds_read_b64 v[172:173], v22 offset:8448
    v_mfma_f32_16x16x32_bf16 v[52:55], a[52:55], v[140:143], v[52:55]
    ds_read_b64 v[174:175], v23 offset:8448
    v_mfma_f32_16x16x32_bf16 v[56:59], a[48:51], v[144:147], v[56:59]
    ds_read_b64 v[176:177], v22 offset:40960
    v_mfma_f32_16x16x32_bf16 v[60:63], a[52:55], v[144:147], v[60:63]
    ds_read_b64 v[178:179], v23 offset:40960
    s_waitcnt lgkmcnt(12)
    v_mfma_f32_16x16x32_bf16 v[64:67], a[48:51], v[148:151], v[64:67]
    ds_read_b64 v[180:181], v22 offset:41216
    v_mfma_f32_16x16x32_bf16 v[68:71], a[52:55], v[148:151], v[68:71]
    ds_read_b64 v[182:183], v23 offset:41216
    v_mfma_f32_16x16x32_bf16 v[40:43], a[56:59], v[152:155], v[40:43]
    ds_read_b64 v[136:137], v24 offset:8192
    v_mfma_f32_16x16x32_bf16 v[44:47], a[60:63], v[152:155], v[44:47]
    ds_read_b64 v[138:139], v25 offset:8192
    s_waitcnt lgkmcnt(11)
    v_mfma_f32_16x16x32_bf16 v[48:51], a[56:59], v[156:159], v[48:51]
    ds_read_b64 v[140:141], v24 offset:8448
    v_mfma_f32_16x16x32_bf16 v[52:55], a[60:63], v[156:159], v[52:55]
    ds_read_b64 v[142:143], v25 offset:8448
    v_mfma_f32_16x16x32_bf16 v[56:59], a[56:59], v[160:163], v[56:59]
    ds_read_b64 v[144:145], v24 offset:40960
    v_mfma_f32_16x16x32_bf16 v[60:63], a[60:63], v[160:163], v[60:63]
    ds_read_b64 v[146:147], v25 offset:40960
    s_waitcnt lgkmcnt(11)
    v_mfma_f32_16x16x32_bf16 v[64:67], a[56:59], v[164:167], v[64:67]
    ds_read_b64 v[148:149], v24 offset:41216
    v_mfma_f32_16x16x32_bf16 v[68:71], a[60:63], v[164:167], v[68:71]
    ds_read_b64 v[150:151], v25 offset:41216
    s_waitcnt vmcnt(5)
    s_barrier
    v_mfma_f32_16x16x32_bf16 v[40:43], a[64:67], v[168:171], v[40:43]
    ds_read_b64 v[152:153], v26 offset:8192
    v_mfma_f32_16x16x32_bf16 v[44:47], a[68:71], v[168:171], v[44:47]
    ds_read_b64 v[154:155], v27 offset:8192
    s_waitcnt lgkmcnt(10)
    v_mfma_f32_16x16x32_bf16 v[48:51], a[64:67], v[172:175], v[48:51]
    ds_read_b64 v[156:157], v26 offset:8448
    v_mfma_f32_16x16x32_bf16 v[52:55], a[68:71], v[172:175], v[52:55]
    ds_read_b64 v[158:159], v27 offset:8448
    v_mfma_f32_16x16x32_bf16 v[56:59], a[64:67], v[176:179], v[56:59]
    ds_read_b64 v[160:161], v26 offset:40960
    v_mfma_f32_16x16x32_bf16 v[60:63], a[68:71], v[176:179], v[60:63]
    ds_read_b64 v[162:163], v27 offset:40960
    v_mfma_f32_16x16x32_bf16 v[64:67], a[64:67], v[180:183], v[64:67]
    ds_read_b64 v[164:165], v26 offset:41216
    v_mfma_f32_16x16x32_bf16 v[68:71], a[68:71], v[180:183], v[68:71]
    ds_read_b64 v[166:167], v27 offset:41216
    s_waitcnt lgkmcnt(10)
    v_mfma_f32_16x16x32_bf16 v[40:43], a[72:75], v[136:139], v[40:43]
    ds_read_b64 v[168:169], v32 offset:8192
    v_mfma_f32_16x16x32_bf16 v[44:47], a[76:79], v[136:139], v[44:47]
    ds_read_b64 v[170:171], v33 offset:8192
    v_mfma_f32_16x16x32_bf16 v[48:51], a[72:75], v[140:143], v[48:51]
    ds_read_b64 v[172:173], v32 offset:8448
    v_mfma_f32_16x16x32_bf16 v[52:55], a[76:79], v[140:143], v[52:55]
    ds_read_b64 v[174:175], v33 offset:8448
    v_mfma_f32_16x16x32_bf16 v[56:59], a[72:75], v[144:147], v[56:59]
    ds_read_b64 v[176:177], v32 offset:40960
    v_mfma_f32_16x16x32_bf16 v[60:63], a[76:79], v[144:147], v[60:63]
    ds_read_b64 v[178:179], v33 offset:40960
    s_waitcnt lgkmcnt(12)
    v_mfma_f32_16x16x32_bf16 v[64:67], a[72:75], v[148:151], v[64:67]
    ds_read_b64 v[180:181], v32 offset:41216
    v_mfma_f32_16x16x32_bf16 v[68:71], a[76:79], v[148:151], v[68:71]
    ds_read_b64 v[182:183], v33 offset:41216
    s_waitcnt vmcnt(1)
    s_barrier
    v_mfma_f32_16x16x32_bf16 v[40:43], a[80:83], v[152:155], v[40:43]
    ds_read_b64 v[136:137], v34 offset:8192
    ds_read_b64_tr_b16 a[96:97], v14 offset:32768
    v_mfma_f32_16x16x32_bf16 v[44:47], a[84:87], v[152:155], v[44:47]
    ds_read_b64 v[138:139], v35 offset:8192
    ds_read_b64_tr_b16 a[98:99], v14 offset:33792
    s_waitcnt lgkmcnt(12)
    v_mfma_f32_16x16x32_bf16 v[48:51], a[80:83], v[156:159], v[48:51]
    ds_read_b64 v[140:141], v34 offset:8448
    ds_read_b64_tr_b16 a[100:101], v15 offset:32768
    v_mfma_f32_16x16x32_bf16 v[52:55], a[84:87], v[156:159], v[52:55]
    ds_read_b64 v[142:143], v35 offset:8448
    ds_read_b64_tr_b16 a[102:103], v15 offset:33792
    v_mfma_f32_16x16x32_bf16 v[56:59], a[80:83], v[160:163], v[56:59]
    ds_read_b64 v[144:145], v34 offset:40960
    ds_read_b64_tr_b16 a[104:105], v14 offset:40960
    v_mfma_f32_16x16x32_bf16 v[60:63], a[84:87], v[160:163], v[60:63]
    ds_read_b64 v[146:147], v35 offset:40960
    ds_read_b64_tr_b16 a[106:107], v14 offset:41984
    v_mfma_f32_16x16x32_bf16 v[64:67], a[80:83], v[164:167], v[64:67]
    ds_read_b64 v[148:149], v34 offset:41216
    ds_read_b64_tr_b16 a[108:109], v15 offset:40960
    v_mfma_f32_16x16x32_bf16 v[68:71], a[84:87], v[164:167], v[68:71]
    ds_read_b64 v[150:151], v35 offset:41216
    ds_read_b64_tr_b16 a[110:111], v15 offset:41984
    s_waitcnt lgkmcnt(15)
    v_mfma_f32_16x16x32_bf16 v[40:43], a[88:91], v[168:171], v[40:43]
    ds_read_b64 v[152:153], v254 offset:8192
    ds_read_b64 v[154:155], v255 offset:8192
    v_mfma_f32_16x16x32_bf16 v[44:47], a[92:95], v[168:171], v[44:47]
    ds_read_b64 v[156:157], v254 offset:8448
    ds_read_b64 v[158:159], v255 offset:8448
    s_waitcnt lgkmcnt(15)
    v_mfma_f32_16x16x32_bf16 v[40:43], a[96:99], v[136:139], v[40:43]
    ds_read_b64 v[160:161], v254 offset:40960
    ds_read_b64 v[162:163], v255 offset:40960
    s_waitcnt lgkmcnt(14)
    v_mfma_f32_16x16x32_bf16 v[44:47], a[100:103], v[136:139], v[44:47]
    ds_read_b64 v[164:165], v254 offset:41216
    ds_read_b64 v[166:167], v255 offset:41216
    v_mfma_f32_16x16x32_bf16 v[48:51], a[88:91], v[172:175], v[48:51]
    v_mfma_f32_16x16x32_bf16 v[52:55], a[92:95], v[172:175], v[52:55]
    v_mfma_f32_16x16x32_bf16 v[48:51], a[96:99], v[140:143], v[48:51]
    v_mfma_f32_16x16x32_bf16 v[52:55], a[100:103], v[140:143], v[52:55]
    v_mfma_f32_16x16x32_bf16 v[56:59], a[88:91], v[176:179], v[56:59]
    s_waitcnt lgkmcnt(6)
    v_mfma_f32_16x16x32_bf16 v[40:43], a[104:107], v[152:155], v[40:43]
    v_mfma_f32_16x16x32_bf16 v[44:47], a[108:111], v[152:155], v[44:47]
    s_waitcnt lgkmcnt(4)
    v_mfma_f32_16x16x32_bf16 v[48:51], a[104:107], v[156:159], v[48:51]
    s_nop 4
    v_cvt_pk_bf16_f32 v40, v40, v41
    v_mfma_f32_16x16x32_bf16 v[52:55], a[108:111], v[156:159], v[52:55]
    v_cvt_pk_bf16_f32 v41, v42, v43
    v_cvt_pk_bf16_f32 v44, v44, v45
    v_mfma_f32_16x16x32_bf16 v[60:63], a[92:95], v[176:179], v[60:63]
    ds_write_b64 v236, v[40:41] offset:0
    v_mfma_f32_16x16x32_bf16 v[56:59], a[96:99], v[144:147], v[56:59]
    v_cvt_pk_bf16_f32 v45, v46, v47
    v_cvt_pk_bf16_f32 v48, v48, v49
    v_mfma_f32_16x16x32_bf16 v[60:63], a[100:103], v[144:147], v[60:63]
    ds_write_b64 v237, v[44:45] offset:0
    s_waitcnt lgkmcnt(4)
    v_mfma_f32_16x16x32_bf16 v[56:59], a[104:107], v[160:163], v[56:59]
    ds_read_b128 v[104:107], v240 offset:0
    v_mfma_f32_16x16x32_bf16 v[60:63], a[108:111], v[160:163], v[60:63]
    v_cvt_pk_bf16_f32 v49, v50, v51
    v_cvt_pk_bf16_f32 v52, v52, v53
    v_mfma_f32_16x16x32_bf16 v[64:67], a[88:91], v[180:183], v[64:67]
    ds_write_b64 v236, v[48:49] offset:1024
    v_mfma_f32_16x16x32_bf16 v[64:67], a[96:99], v[148:151], v[64:67]
    v_cvt_pk_bf16_f32 v53, v54, v55
    v_cvt_pk_bf16_f32 v56, v56, v57
    v_mfma_f32_16x16x32_bf16 v[68:71], a[92:95], v[180:183], v[68:71]
    ds_write_b64 v237, v[52:53] offset:1024
    s_waitcnt lgkmcnt(5)
    v_mfma_f32_16x16x32_bf16 v[64:67], a[104:107], v[164:167], v[64:67]
    ds_read_b128 v[108:111], v240 offset:1024
    v_mfma_f32_16x16x32_bf16 v[68:71], a[100:103], v[148:151], v[68:71]
    v_cvt_pk_bf16_f32 v57, v58, v59
    v_cvt_pk_bf16_f32 v60, v60, v61
    v_mfma_f32_16x16x32_bf16 v[68:71], a[108:111], v[164:167], v[68:71]
    ds_write_b64 v236, v[56:57] offset:2048
    v_cvt_pk_bf16_f32 v61, v62, v63
    s_waitcnt lgkmcnt(4)
    buffer_store_dwordx4 v[104:107], v241, s[44:47], s64 offen sc1
    ds_write_b64 v237, v[60:61] offset:2048
    ds_read_b128 v[112:115], v240 offset:2048
    v_cvt_pk_bf16_f32 v64, v64, v65
    v_cvt_pk_bf16_f32 v65, v66, v67
    ds_write_b64 v236, v[64:65] offset:3072
    v_cvt_pk_bf16_f32 v68, v68, v69
    v_cvt_pk_bf16_f32 v69, v70, v71
    ds_write_b64 v237, v[68:69] offset:3072
    s_waitcnt lgkmcnt(5)
    buffer_store_dwordx4 v[108:111], v241, s[44:47], s65 offen sc1
    ds_read_b128 v[116:119], v240 offset:3072
    s_waitcnt lgkmcnt(3)
    buffer_store_dwordx4 v[112:115], v241, s[44:47], s66 offen sc1
    s_waitcnt lgkmcnt(0)
    buffer_store_dwordx4 v[116:119], v241, s[44:47], s67 offen sc1
L_endA:
    s_endpgm
L_repollA:
    buffer_load_dwordx2 v[232:233], v13, s[40:43], s97 offen sc1
    s_add_u32 s71, s71, 1
    s_cmp_gt_u32 s71, 0x100000
    s_cbranch_scc1 L_endA
    s_nop 15
    buffer_load_dwordx2 v[246:247], v13, s[40:43], s97 offen sc1
    s_waitcnt vmcnt(1)
    v_xor_b32 v232, s58, v232
    v_xor_b32 v233, s59, v233
    v_or_b32 v232, v232, v233
    v_cmp_ne_u32 vcc, 0, v232
    s_nop 1
    s_andn2_b64 vcc, vcc, s[74:75]
    s_cbranch_vccz L_seen2A
    s_waitcnt vmcnt(0)
    v_xor_b32 v246, s58, v246
    v_xor_b32 v247, s59, v247
    v_or_b32 v246, v246, v247
    v_cmp_ne_u32 vcc, 0, v246
    s_nop 1
    s_andn2_b64 vcc, vcc, s[74:75]
    s_cbranch_vccnz L_repollA
L_seen2A:
    s_waitcnt vmcnt(0)
    s_branch L_seenA
L_farA:
    s_waitcnt vmcnt(0)
    s_nop 4
    s_add_u32 m0, s80, 114688
    s_add_u32 s57, s57, 57344
    buffer_store_dwordx4 v[104:107], v249, s[40:43], s90 offen sc1
    buffer_store_dwordx4 v[108:111], v249, s[40:43], s86 offen sc1
    buffer_store_dwordx4 v[120:123], v249, s[40:43], s96 offen sc1
    s_lshl_b32 s56, s49, 2
    s_add_u32 s56, s56, s84
    s_mul_i32 s89, s56, 114688
    s_mul_i32 s56, s48, 896
    buffer_store_dwordx4 v[124:127], v249, s[40:43], s87 offen sc1
    s_add_u32 s89, s89, s56
    s_lshl_b32 s56, s83, 2
    s_add_u32 s56, s56, s51
    s_cmp_ge_u32 s56, 14
    s_cselect_b32 s86, 0x40000000, 0
    s_lshl_b32 s56, s56, 6
    s_add_u32 s64, s89, s56
    s_add_u32 s65, s64, 28672
    s_add_u32 s66, s64, 57344
    s_add_u32 s67, s64, 86016
    s_lshl_b32 s87, s51, 12
    v_and_b32 v242, 15, v1
    s_add_u32 s87, s87, 65536
    v_lshlrev_b32 v235, 4, v242
    v_lshl_add_u32 v242, v242, 6, s87
    v_bfe_u32 v243, v1, 4, 1
    buffer_load_dwordx4 v252, s[32:35], s57 offen offset:0  lds
    v_lshl_add_u32 v242, v243, 3, v242
    v_bfe_u32 v243, v1, 1, 2
    v_lshrrev_b32 v244, 5, v1
    v_xor_b32 v243, v243, v244
    v_lshl_add_u32 v236, v243, 4, v242
    v_bfe_u32 v243, v1, 3, 2
    v_xor_b32 v243, v243, v1
    v_lshrrev_b32 v242, 2, v1
    v_and_b32 v243, 3, v243
    v_lshl_add_u32 v244, v242, 6, s87
    v_lshl_add_u32 v240, v243, 4, v244
    s_and_b32 s56, s85, 127
    v_mul_u32_u24 v242, 1792, v242
    buffer_load_dwordx4 v3, s[32:35], s57 offen offset:1024  lds
    v_and_b32 v243, 3, v1
    s_or_b32 s56, s56, s51
    v_lshl_add_u32 v242, v243, 4, v242
    s_cmp_eq_u32 s56, 0
    v_add_u32 v241, s86, v242
    s_cselect_b32 s56, 0, 0x20000000
    s_lshl_b32 s86, s48, 7
    s_or_b32 s56, s56, s86
    v_add_u32 v234, s56, v19
    s_lshl2_add_u32 s56, s52, s84
    s_lshl2_add_u32 s56, s56, s51
    s_lshl_b32 s56, s56, 14
    s_add_u32 s89, s56, 2097152
    v_and_b32 v242, 15, v1
    buffer_load_dwordx4 v4, s[32:35], s57 offen offset:2048  lds
    s_lshl_b32 s91, s51, 14
    v_xor_b32 v237, 32, v236
    v_cmp_eq_u32_e64 s[74:75], s50, v242
    v_add_u32 v20, v20, v235
    v_add_u32 v21, v21, v235
    v_add_u32 v22, v22, v235
    v_add_u32 v23, v23, v235
    v_add_u32 v24, v24, v235
    v_add_u32 v25, v25, v235
    v_add_u32 v26, v26, v235
    v_add_u32 v27, v27, v235
    v_add_u32 v32, v32, v235
    v_add_u32 v33, v33, v235
    v_add_u32 v34, v34, v235
    buffer_load_dwordx4 v5, s[32:35], s57 offen offset:3072  lds
    v_add_u32 v35, v35, v235
    v_add_u32 v254, v254, v235
    v_add_u32 v255, v255, v235
    s_mov_b32 m0, s91
    s_waitcnt vmcnt(4)
    buffer_store_dwordx2 v[38:39], v19, s[40:43], s88 offen sc1
    s_branch L_joinA
L_part_retryA:
    s_waitcnt vmcnt(0)
    s_add_u32 s71, s71, 1
    s_cmp_gt_u32 s71, 0x100000
    s_cbranch_scc1 L_endA
    buffer_load_dwordx2 v[38:39], v13, s[40:43], s8 offen sc1
    v_xor_b32 v232, v203, v248
    v_cmp_lt_u32 vcc, 0xffff, v232
    s_nop 1
    s_cbranch_vccz L_gotA0
    buffer_load_dwordx4 v[200:203], v10, s[40:43], s5 offen offset:0 sc1
L_gotA0:
    v_xor_b32 v232, v207, v248
    v_cmp_lt_u32 vcc, 0xffff, v232
    s_nop 1
    s_cbranch_vccz L_gotA1
    buffer_load_dwordx4 v[204:207], v10, s[40:43], s5 offen offset:256 sc1
L_gotA1:
    v_xor_b32 v232, v211, v248
    v_cmp_lt_u32 vcc, 0xffff, v232
    s_nop 1
    s_cbranch_vccz L_gotA2
    buffer_load_dwordx4 v[208:211], v10, s[40:43], s5 offen offset:512 sc1
L_gotA2:
    v_xor_b32 v232, v215, v248
    v_cmp_lt_u32 vcc, 0xffff, v232
    s_nop 1
    s_cbranch_vccz L_gotA3
    buffer_load_dwordx4 v[212:215], v10, s[40:43], s5 offen offset:768 sc1
L_gotA3:
    v_xor_b32 v232, v219, v248
    v_cmp_lt_u32 vcc, 0xffff, v232
    s_nop 1
    s_cbranch_vccz L_gotA4
    buffer_load_dwordx4 v[216:219], v10, s[40:43], s6 offen offset:0 sc1
L_gotA4:
    v_xor_b32 v232, v223, v248
    v_cmp_lt_u32 vcc, 0xffff, v232
    s_nop 1
    s_cbranch_vccz L_gotA5
    buffer_load_dwordx4 v[220:223], v10, s[40:43], s6 offen offset:256 sc1
L_gotA5:
    v_xor_b32 v232, v227, v248
    v_cmp_lt_u32 vcc, 0xffff, v232
    s_nop 1
    s_cbranch_vccz L_gotA6
    buffer_load_dwordx4 v[224:227], v10, s[40:43], s6 offen offset:512 sc1
L_gotA6:
    v_xor_b32 v232, v231, v248
    v_cmp_lt_u32 vcc, 0xffff, v232
    s_nop 1
    s_cbranch_vccz L_gotA7
    buffer_load_dwordx4 v[228:231], v10, s[40:43], s6 offen offset:768 sc1
L_gotA7:
    s_waitcnt vmcnt(0)
    s_branch L_part_chkA
    .p2align 6
    .type L_tabA,@object
L_tabA:
    .long 0
    .long 512
    .long 1536
    .long 1032
    .long 2056
    .long 2568
    .long 3592
    .long 19456
    .long 20480
    .long 20992
    .long 22016
    .long 21512
    .long 22536
    .long 7168
    .long 8192
    .long 8704
    .long 8
    .long 520
    .long 1544
    .long 17408
    .long 18432
    .long 18944
    .long 19968
    .long 19464
    .long 20488
    .long 5120
    .long 6144
    .long 6656
    .long 7680
    .long 7176
    .long 8200
    .long 8712
    .long 16384
    .long 16896
    .long 17920
    .long 17416
    .long 18440
    .long 3072
    .long 4096
    .long 4608
    .long 5632
    .long 5128
    .long 6152
    .long 6664
    .long 7688
    .long 23552
    .long 24576
    .long 25088
    .long 16392
    .long 1024
    .long 2048
    .long 2560
    .long 3584
    .long 3080
    .long 4104
    .long 4616
    .long 5640
    .long 21504
    .long 22528
    .long 23040
    .long 24064
    .long 23560
    .long 24584
    .long 9216
    .fill 4528, 4, 0
    .size L_tabA, 256 + 4 * 4528
.section .rodata,"a"
.p2align 6
.amdhsa_kernel concat_heads__linear_attn_block__linear_kernel_hedgehog__prompt_kernel
  .amdhsa_next_free_vgpr 512
  .amdhsa_next_free_sgpr 102
  .amdhsa_accum_offset 256
  .amdhsa_group_segment_fixed_size 0
  .amdhsa_kernarg_size 80
  .amdhsa_user_sgpr_count 2
  .amdhsa_user_sgpr_kernarg_segment_ptr 1
  .amdhsa_system_sgpr_workgroup_id_x 1
.end_amdhsa_kernel
```
